```python
import torch

def _softmax(x, axis=-1):
    return torch.softmax(x, dim=axis)

def _gelu(x):
    return torch.nn.functional.gelu(x, approximate='tanh')

def _silu(x):
    return torch.nn.functional.silu(x)

def _sigmoid(x):
    return torch.sigmoid(x)

def _layernorm(x, axis=-1, eps=1e-05):
    m = x.mean(dim=axis, keepdim=True)
    v = x.var(dim=axis, keepdim=True, unbiased=False)
    return (x - m) / torch.sqrt(v + eps)

def _scatter_add(tgt, idx, src, axis=0):
    return tgt.clone().index_add_(axis, idx, src)

def _segment_sum(src, seg, n):
    out = torch.zeros((n,) + src.shape[1:], dtype=src.dtype)
    return out.index_add_(0, seg, src)

def _pad(x, pw):
    flat = tuple((v for pair in reversed(pw) for v in pair))
    return torch.nn.functional.pad(x, flat)
kernel_name = 'adaLN_cond__ssm_conv_s4__mixer_s_mlp__prompt'

def setup_inputs():

    _w = lambda a: (lambda t: t.to(torch.bfloat16) if t.is_floating_point() else t)(torch.as_tensor(a))

    def _A_setup():
        B, L, D, N = (1, 2048, 512, 128)
        A_re = -(lambda _x: torch.exp(torch.as_tensor(_x)))((lambda *s: torch.randn(*s, dtype=torch.bfloat16) * 3.2)(D, N))
        A_im = torch.pi * (lambda *s: torch.randn(*s, dtype=torch.bfloat16) * 0.1)(D, N)
        B_re = (lambda *s: torch.randn(*s, dtype=torch.bfloat16) * 0.2)(D, N)
        B_im = (lambda *s: torch.randn(*s, dtype=torch.bfloat16) * 0.2)(D, N)
        C_re = (lambda *s: torch.randn(*s, dtype=torch.bfloat16) * 0.2)(D, N)
        C_im = (lambda *s: torch.randn(*s, dtype=torch.bfloat16) * 0.2)(D, N)
        log_dt = (lambda *s: torch.randn(*s, dtype=torch.bfloat16) * 0.1)(D) * 0.5 - 4.0
        Dskip = (lambda *s: torch.randn(*s, dtype=torch.bfloat16) * 0.1)(D)
        return {'u': _w((lambda *s: torch.randn(*s, dtype=torch.bfloat16) * 0.05)(B, L, D)), 'A_re': _w(A_re), 'A_im': _w(A_im), 'B_re': _w(B_re), 'B_im': _w(B_im), 'C_re': _w(C_re), 'C_im': _w(C_im), 'log_dt': _w(log_dt), 'Dskip': _w(Dskip)}
    _A_in = _A_setup()

    def _B_setup():
        B, S, D, F = (1, 2048, 512, 1376)
        return {'x': _w((lambda *s: torch.randn(*s, dtype=torch.bfloat16) * 0.05)(B, S, D)), 'w1': _w((lambda *s: torch.randn(*s, dtype=torch.bfloat16) * 3.2)(D, D) * D ** (-0.5)), 'w2': _w((lambda *s: torch.randn(*s, dtype=torch.bfloat16) * 3.2)(D, D) * D ** (-0.5)), 'w3': _w((lambda *s: torch.randn(*s, dtype=torch.bfloat16) * 3.2)(D, F) * D ** (-0.5)), 'w4': _w((lambda *s: torch.randn(*s, dtype=torch.bfloat16) * 1.6)(F, D) * F ** (-0.5))}
    _B_in = _B_setup()
    return {'A_u': _A_in['u'], 'A_A_re': _A_in['A_re'], 'A_A_im': _A_in['A_im'], 'A_B_re': _A_in['B_re'], 'A_B_im': _A_in['B_im'], 'A_C_re': _A_in['C_re'], 'A_C_im': _A_in['C_im'], 'A_log_dt': _A_in['log_dt'], 'A_Dskip': _A_in['Dskip'], 'B_x': _B_in['x'], 'B_w1': _B_in['w1'], 'B_w2': _B_in['w2'], 'B_w3': _B_in['w3'], 'B_w4': _B_in['w4'], 'c': _w((lambda *s: torch.randn(*s, dtype=torch.bfloat16) * 0.1)(1, 512) * 8.0), 'w_mod': _w((lambda *s: torch.randn(*s, dtype=torch.bfloat16) * 0.1)(512, 6 * 512) * 512 ** (-0.5) * 8.0)}

def reference(A_u, A_A_re, A_A_im, A_B_re, A_B_im, A_C_re, A_C_im, A_log_dt, A_Dskip, B_x, B_w1, B_w2, B_w3, B_w4, c, w_mod):

    def _A_ref(u, A_re, A_im, B_re, B_im, C_re, C_im, log_dt, Dskip):
        Bsz, L, D = u.shape
        dt = torch.exp(log_dt)[:, None]
        A = A_re + 1j * A_im
        Bc = B_re + 1j * B_im
        Cc = C_re + 1j * C_im
        logdA = dt * A
        dB = dt * Bc
        l = (lambda x, dt: x.to(dt))(torch.arange(L), A_re.dtype)
        P = torch.exp(logdA[:, :, None] * l[None, None, :])
        K = torch.einsum('dn,dnl,dn->dl', Cc, P, dB).real
        L2 = 2 * L
        Kp = _pad(K, ((0, 0), (0, L)))
        up = (lambda x, *d: x.permute(*d))(u, 0, 2, 1)
        up = _pad(up, ((0, 0), (0, 0), (0, L)))
        Kf = (lambda x, axes=(-2, -1): torch.fft.rfft2(x.float(), dim=axes))(Kp[:, None, :], axes=(-2, -1))
        Uf = (lambda x, axes=(-2, -1): torch.fft.rfft2(x.float(), dim=axes))(up[:, :, None, :], axes=(-2, -1))
        Yf = Uf * Kf[None, :, :, :]
        y = (lambda x, s, axes=(-2, -1): torch.fft.irfft2(x, s=s, dim=axes).to(torch.bfloat16))(Yf, (1, L2), axes=(-2, -1))[:, :, 0, :L]
        y = (lambda x, *d: x.permute(*d))(y, 0, 2, 1) + u * Dskip[None, None, :]
        return y

    def _B_ref(x, w1, w2, w3, w4):
        B, S, D = x.shape
        h = _gelu(_layernorm(x, axis=-1) @ w1)
        c = D // 4
        g0 = _pad(h[:, :, 0 * c:1 * c], ((0, 0), (1, 0), (0, 0)))[:, :S, :]
        g1 = _pad(h[:, :, 1 * c:2 * c], ((0, 0), (0, 1), (0, 0)))[:, 1:, :]
        g2 = _pad(h[:, :, 2 * c:3 * c], ((0, 0), (2, 0), (0, 0)))[:, :S, :]
        g3 = _pad(h[:, :, 3 * c:], ((0, 0), (0, 2), (0, 0)))[:, 2:, :]
        hs = torch.concatenate([g0, g1, g2, g3], axis=-1) @ w2
        x1 = x + hs
        h2 = _gelu(_layernorm(x1, axis=-1) @ w3) @ w4
        return x1 + h2
    x = A_u
    mod = (_silu(c) @ w_mod).reshape(c.shape[0], 6, 1, -1)
    sa, ca, ga, sb, cb, gb = (mod[:, 0].clone(), mod[:, 1].clone(), mod[:, 2].clone(), mod[:, 3].clone(), mod[:, 4].clone(), mod[:, 5].clone())
    h = _layernorm(x, axis=-1) * (1 + ca) + sa
    x = x + ga * _A_ref(h, A_A_re, A_A_im, A_B_re, A_B_im, A_C_re, A_C_im, A_log_dt, A_Dskip)
    h = _layernorm(x, axis=-1) * (1 + cb) + sb
    x = x + gb * _B_ref(h, B_w1, B_w2, B_w3, B_w4)
    return x
```

```asm
; @launch grid=(256,1,1) block=(512,1,1) lds=163840
.amdgcn_target "amdgcn-amd-amdhsa--gfx950"
.text
.globl adaLN_cond__ssm_conv_s4__mixer_s_mlp__prompt_kernel
.p2align 8
.type adaLN_cond__ssm_conv_s4__mixer_s_mlp__prompt_kernel,@function
adaLN_cond__ssm_conv_s4__mixer_s_mlp__prompt_kernel:
    s_cmp_ge_u32 s2, 256
    s_cbranch_scc1 L_END
    s_load_dwordx2 s[8:9], s[0:1], 0
    s_load_dwordx2 s[12:13], s[0:1], 144
    s_load_dwordx2 s[20:21], s[0:1], 8
    s_load_dwordx2 s[24:25], s[0:1], 16
    s_load_dwordx2 s[28:29], s[0:1], 24
    s_load_dwordx2 s[32:33], s[0:1], 32
    s_load_dwordx2 s[36:37], s[0:1], 40
    s_load_dwordx2 s[40:41], s[0:1], 48
    s_load_dwordx2 s[44:45], s[0:1], 56
    s_load_dwordx2 s[52:53], s[0:1], 112
    s_load_dwordx2 s[56:57], s[0:1], 120
    s_load_dwordx2 s[60:61], s[0:1], 80
    s_load_dwordx2 s[64:65], s[0:1], 88
    s_load_dwordx2 s[68:69], s[0:1], 96
    s_load_dwordx2 s[72:73], s[0:1], 104
    s_load_dwordx2 s[48:49], s[0:1], 64
    s_load_dwordx2 s[16:17], s[0:1], 128
    v_lshrrev_b32 v2, 6, v0
    v_and_b32 v1, 63, v0
    v_readfirstlane_b32 s5, v2
    s_mov_b32 s10, 2097152
    s_mov_b32 s11, 0x20000
    s_mov_b32 s22, 131072
    s_mov_b32 s23, 0x20000
    s_mov_b32 s26, 131072
    s_mov_b32 s27, 0x20000
    s_mov_b32 s30, 131072
    s_mov_b32 s31, 0x20000
    s_mov_b32 s34, 131072
    s_mov_b32 s35, 0x20000
    s_mov_b32 s38, 131072
    s_mov_b32 s39, 0x20000
    s_mov_b32 s42, 131072
    s_mov_b32 s43, 0x20000
    s_mov_b32 s46, 1024
    s_mov_b32 s47, 0x20000
    s_mov_b32 s50, 1024
    s_mov_b32 s51, 0x20000
    s_mov_b32 s62, 524288
    s_mov_b32 s63, 0x20000
    s_mov_b32 s66, 524288
    s_mov_b32 s67, 0x20000
    s_mov_b32 s70, 1409024
    s_mov_b32 s71, 0x20000
    s_mov_b32 s74, 1409024
    s_mov_b32 s75, 0x20000
    s_mov_b32 s54, 1024
    s_mov_b32 s55, 0x20000
    s_mov_b32 s58, 3145728
    s_mov_b32 s59, 0x20000
    s_mov_b32 s18, 2097152
    s_mov_b32 s19, 0x20000
    s_mov_b32 s14, 21430272
    s_mov_b32 s15, 0x20000
    v_and_b32 v2, 15, v1
    v_lshrrev_b32 v3, 4, v1
    v_lshlrev_b32 v4, 4, v1
    s_and_b32 s6, s2, 7
    s_lshr_b32 s7, s2, 3
    s_lshl_b32 s76, s6, 6
    s_lshl_b32 s80, s7, 1
    s_add_u32 s76, s76, s80
    s_lshl_b32 s77, s6, 2
    s_lshr_b32 s80, s7, 3
    s_add_u32 s77, s77, s80
    s_and_b32 s78, s7, 7
    s_lshl_b32 s100, s77, 1
    s_and_b32 s80, s78, 1
    s_add_u32 s100, s100, s80
    s_lshr_b32 s101, s78, 1
    v_mov_b32 v102, 0
    v_mov_b32 v154, 0
    v_mov_b32 v155, 0
    s_waitcnt lgkmcnt(0)
    s_mov_b64 s[92:93], s[60:61]
    s_mov_b32 s94, 524288
    s_mov_b32 s95, 0x20000
    s_cmp_lt_u32 s5, 4
    s_cbranch_scc1 L_roleK
    s_setprio 2
    s_cmp_eq_u32 s5, 7
    s_cbranch_scc1 L_role7
    s_cmp_ge_u32 s5, 5
    s_cbranch_scc1 L_role56
    s_lshl_b32 s80, s2, 13
    s_add_u32 s81, s80, 4096
    buffer_load_dwordx4 v[24:27], v4, s[8:11], s80 offen
    buffer_load_dwordx4 v[28:31], v4, s[8:11], s80 offen offset:1024
    buffer_load_dwordx4 v[32:35], v4, s[8:11], s80 offen offset:2048
    buffer_load_dwordx4 v[36:39], v4, s[8:11], s80 offen offset:3072
    buffer_load_dwordx4 v[40:43], v4, s[8:11], s81 offen
    buffer_load_dwordx4 v[44:47], v4, s[8:11], s81 offen offset:1024
    buffer_load_dwordx4 v[48:51], v4, s[8:11], s81 offen offset:2048
    buffer_load_dwordx4 v[52:55], v4, s[8:11], s81 offen offset:3072
    s_getpc_b64 s[92:93]
L_pc:
    s_sub_u32 s92, s92, L_pc-adaLN_cond__ssm_conv_s4__mixer_s_mlp__prompt_kernel
    s_subb_u32 s93, s93, 0
    s_mov_b32 s94, L_END-adaLN_cond__ssm_conv_s4__mixer_s_mlp__prompt_kernel
    s_mov_b32 s95, 0x20000
    s_mul_i32 s80, s7, 1024
    v_lshlrev_b32 v126, 7, v1
    v_min_u32 v126, 896, v126
    buffer_load_dword v127, v126, s[92:95], s80 offen
    s_load_dword s4, s[12:13], 0
    v_lshlrev_b32 v5, 4, v2
    v_lshl_add_u32 v5, v3, 9, v5
    v_and_b32 v16, 255, v0
    v_lshlrev_b32 v16, 3, v16
    s_lshr_b32 s80, s5, 2
    s_mul_i32 s80, s80, 5120
    s_add_u32 s80, s80, 69632
    v_cvt_f32_u32 v17, s80
    s_add_u32 s80, s80, 5118
    v_mov_b32 v18, s80
    v_cvt_f32_u32 v19, v16
    v_cmp_eq_u32 vcc, 0, v16
    v_add_f32 v20, 0xc0400000, v19
    v_cvt_pk_bf16_f32 v20, v20, v20
    v_and_b32 v20, 0xffff0000, v20
    v_fma_f32 v20, v20, 2.0, v17
    v_cvt_u32_f32 v113, v20
    v_cndmask_b32 v113, v113, v18, vcc
    v_add_f32 v20, -2.0, v19
    v_cvt_pk_bf16_f32 v20, v20, v20
    v_and_b32 v20, 0xffff0000, v20
    v_fma_f32 v20, v20, 2.0, v17
    v_cvt_u32_f32 v114, v20
    v_cndmask_b32 v114, v114, v18, vcc
    v_add_f32 v20, -1.0, v19
    v_cvt_pk_bf16_f32 v20, v20, v20
    v_and_b32 v20, 0xffff0000, v20
    v_fma_f32 v20, v20, 2.0, v17
    v_cvt_u32_f32 v115, v20
    v_cndmask_b32 v115, v115, v18, vcc
    v_add_f32 v20, 0x0, v19
    v_cvt_pk_bf16_f32 v20, v20, v20
    v_and_b32 v20, 0xffff0000, v20
    v_fma_f32 v20, v20, 2.0, v17
    v_cvt_u32_f32 v116, v20
    v_add_f32 v20, 1.0, v19
    v_cvt_pk_bf16_f32 v20, v20, v20
    v_and_b32 v20, 0xffff0000, v20
    v_fma_f32 v20, v20, 2.0, v17
    v_cvt_u32_f32 v117, v20
    v_add_f32 v20, 2.0, v19
    v_cvt_pk_bf16_f32 v20, v20, v20
    v_and_b32 v20, 0xffff0000, v20
    v_fma_f32 v20, v20, 2.0, v17
    v_cvt_u32_f32 v118, v20
    v_add_f32 v20, 0x40400000, v19
    v_cvt_pk_bf16_f32 v20, v20, v20
    v_and_b32 v20, 0xffff0000, v20
    v_fma_f32 v20, v20, 2.0, v17
    v_cvt_u32_f32 v119, v20
    v_add_f32 v20, 4.0, v19
    v_cvt_pk_bf16_f32 v20, v20, v20
    v_and_b32 v20, 0xffff0000, v20
    v_fma_f32 v20, v20, 2.0, v17
    v_cvt_u32_f32 v120, v20
    v_add_f32 v20, 0x40a00000, v19
    v_cvt_pk_bf16_f32 v20, v20, v20
    v_and_b32 v20, 0xffff0000, v20
    v_fma_f32 v20, v20, 2.0, v17
    v_cvt_u32_f32 v121, v20
    v_add_f32 v20, 0x40c00000, v19
    v_cvt_pk_bf16_f32 v20, v20, v20
    v_and_b32 v20, 0xffff0000, v20
    v_fma_f32 v20, v20, 2.0, v17
    v_cvt_u32_f32 v122, v20
    v_add_f32 v20, 0x40e00000, v19
    v_cvt_pk_bf16_f32 v20, v20, v20
    v_and_b32 v20, 0xffff0000, v20
    v_fma_f32 v20, v20, 2.0, v17
    v_cvt_u32_f32 v123, v20
    s_cmp_ge_u32 s5, 3
    s_cselect_b32 s80, 1, 0
    s_mul_i32 s81, s80, 3
    s_sub_u32 s81, s5, s81
    s_mul_i32 s82, s80, 26112
    s_mul_i32 s83, s81, 8704
    s_add_u32 s82, s82, s83
    v_mul_u32_u24 v16, 544, v2
    v_lshl_add_u32 v16, v3, 4, v16
    v_add_u32 v108, s82, v16
    s_mul_i32 s82, s80, 8704
    s_add_u32 s82, s82, 52224
    v_add_u32 v109, s82, v16
    s_mov_b32 s82, 262144
    s_cmp_eq_u32 s81, 1
    s_cselect_b32 s82, 25166080, s82
    s_cmp_eq_u32 s81, 2
    s_cselect_b32 s82, 100664320, s82
    s_mov_b32 s83, 8650880
    s_cmp_eq_u32 s81, 1
    s_cselect_b32 s83, 33817088, s83
    s_cmp_eq_u32 s81, 2
    s_cselect_b32 s83, 134285312, s83
    s_mov_b32 s87, 16843009
    s_cmp_eq_u32 s81, 1
    s_cselect_b32 s87, 2155872770, s87
    s_cmp_eq_u32 s81, 2
    s_cselect_b32 s87, 2155905152, s87
    v_cmp_gt_u32 vcc, 2, v3
    v_mov_b32 v16, s83
    v_mov_b32 v17, s82
    v_cndmask_b32 v16, v16, v17, vcc
    v_and_b32 v17, 1, v3
    v_lshlrev_b32 v17, 4, v17
    v_bfe_u32 v16, v16, v17, 16
    v_lshlrev_b32 v17, 3, v3
    v_bfe_u32 v17, s87, v17, 8
    v_lshl_add_u32 v16, v2, 3, v16
    s_mul_i32 s82, s80, 5120
    s_add_u32 s82, s82, 69632
    v_lshlrev_b32 v16, 1, v16
    v_add_u32 v104, s82, v16
    v_lshlrev_b32 v17, 1, v17
    v_add_u32 v105, v104, v17
    v_add_u32 v106, v105, v17
    v_add_u32 v107, v106, v17
    s_lshl_b32 s80, s5, 12
    v_add_u32 v9, s80, v4
    v_lshrrev_b32 v16, 3, v1
    v_cmp_gt_u32 vcc, 6, v16
    v_mov_b32 v17, 0
    s_nop 0
    v_cndmask_b32 v16, v17, v16, vcc
    v_lshrrev_b32 v17, 1, v16
    v_lshlrev_b32 v17, 9, v17
    v_and_b32 v16, 1, v16
    v_add_u32 v17, v17, v16
    v_add_u32 v17, s76, v17
    v_and_b32 v16, 7, v1
    v_mul_u32_u24 v16, 3072, v16
    v_add_u32 v17, v17, v16
    v_lshlrev_b32 v10, 3, v17
    s_lshr_b32 s82, s5, 2
    s_and_b32 s83, s5, 3
    s_mul_i32 s80, s82, 4672
    s_lshl_b32 s81, s83, 6
    s_sub_u32 s80, s80, s81
    s_add_u32 s80, s80, 151776
    v_lshlrev_b32 v6, 5, v2
    v_lshl_add_u32 v6, v3, 4, v6
    v_add_u32 v6, s80, v6
    s_mul_i32 s80, s82, 16640
    s_add_u32 s80, s80, s81
    s_add_u32 s80, s80, 79928
    v_lshrrev_b32 v7, 2, v2
    v_mul_u32_u24 v7, 4160, v7
    v_and_b32 v16, 3, v2
    v_lshl_add_u32 v7, v16, 3, v7
    v_lshlrev_b32 v16, 4, v3
    v_sub_u32 v7, v7, v16
    v_add_u32 v7, s80, v7
    s_lshl_b32 s80, s5, 13
    v_add_u32 v8, s80, v4
    v_lshlrev_b32 v16, 4, v2
    v_lshl_add_u32 v16, v3, 2, v16
    s_lshl_b32 s80, s5, 8
    v_add_u32 v16, s80, v16
    v_lshlrev_b32 v11, 2, v16
    v_add_u32 v11, 143360, v11
    v_lshlrev_b32 v12, 1, v16
    v_add_u32 v12, 152064, v12
    v_lshrrev_b32 v13, 1, v2
    v_lshlrev_b32 v13, 15, v13
    v_and_b32 v16, 1, v2
    v_lshl_add_u32 v13, v16, 5, v13
    v_and_b32 v16, 1, v3
    v_lshl_add_u32 v13, v16, 6, v13
    v_lshrrev_b32 v16, 1, v3
    v_lshl_add_u32 v13, v16, 4, v13
    s_waitcnt lgkmcnt(0)
    s_add_u32 s4, s4, 1
    v_mov_b32 v23, 0x3f803f80
    s_waitcnt vmcnt(8)
    s_waitcnt vmcnt(8)
    v_dot2_f32_bf16 v60, v24, v23, 0
    v_dot2_f32_bf16 v68, v24, v24, 0
    v_dot2c_f32_bf16 v60, v25, v23
    v_dot2c_f32_bf16 v68, v25, v25
    v_dot2c_f32_bf16 v60, v26, v23
    v_dot2c_f32_bf16 v68, v26, v26
    v_dot2c_f32_bf16 v60, v27, v23
    v_dot2c_f32_bf16 v68, v27, v27
    s_waitcnt vmcnt(7)
    v_dot2_f32_bf16 v61, v28, v23, 0
    v_dot2_f32_bf16 v69, v28, v28, 0
    v_dot2c_f32_bf16 v61, v29, v23
    v_dot2c_f32_bf16 v69, v29, v29
    v_dot2c_f32_bf16 v61, v30, v23
    v_dot2c_f32_bf16 v69, v30, v30
    v_dot2c_f32_bf16 v61, v31, v23
    v_dot2c_f32_bf16 v69, v31, v31
    s_waitcnt vmcnt(6)
    v_dot2_f32_bf16 v62, v32, v23, 0
    v_dot2_f32_bf16 v70, v32, v32, 0
    v_dot2c_f32_bf16 v62, v33, v23
    v_dot2c_f32_bf16 v70, v33, v33
    v_dot2c_f32_bf16 v62, v34, v23
    v_dot2c_f32_bf16 v70, v34, v34
    v_dot2c_f32_bf16 v62, v35, v23
    v_dot2c_f32_bf16 v70, v35, v35
    s_waitcnt vmcnt(5)
    v_dot2_f32_bf16 v63, v36, v23, 0
    v_dot2_f32_bf16 v71, v36, v36, 0
    v_dot2c_f32_bf16 v63, v37, v23
    v_dot2c_f32_bf16 v71, v37, v37
    v_dot2c_f32_bf16 v63, v38, v23
    v_dot2c_f32_bf16 v71, v38, v38
    v_dot2c_f32_bf16 v63, v39, v23
    v_dot2c_f32_bf16 v71, v39, v39
    s_waitcnt vmcnt(4)
    v_dot2_f32_bf16 v64, v40, v23, 0
    v_dot2_f32_bf16 v72, v40, v40, 0
    v_dot2c_f32_bf16 v64, v41, v23
    v_dot2c_f32_bf16 v72, v41, v41
    v_dot2c_f32_bf16 v64, v42, v23
    v_dot2c_f32_bf16 v72, v42, v42
    v_dot2c_f32_bf16 v64, v43, v23
    v_dot2c_f32_bf16 v72, v43, v43
    s_waitcnt vmcnt(3)
    v_dot2_f32_bf16 v65, v44, v23, 0
    v_dot2_f32_bf16 v73, v44, v44, 0
    v_dot2c_f32_bf16 v65, v45, v23
    v_dot2c_f32_bf16 v73, v45, v45
    v_dot2c_f32_bf16 v65, v46, v23
    v_dot2c_f32_bf16 v73, v46, v46
    v_dot2c_f32_bf16 v65, v47, v23
    v_dot2c_f32_bf16 v73, v47, v47
    s_waitcnt vmcnt(2)
    v_dot2_f32_bf16 v66, v48, v23, 0
    v_dot2_f32_bf16 v74, v48, v48, 0
    v_dot2c_f32_bf16 v66, v49, v23
    v_dot2c_f32_bf16 v74, v49, v49
    v_dot2c_f32_bf16 v66, v50, v23
    v_dot2c_f32_bf16 v74, v50, v50
    v_dot2c_f32_bf16 v66, v51, v23
    v_dot2c_f32_bf16 v74, v51, v51
    s_waitcnt vmcnt(1)
    v_dot2_f32_bf16 v67, v52, v23, 0
    v_dot2_f32_bf16 v75, v52, v52, 0
    v_dot2c_f32_bf16 v67, v53, v23
    v_dot2c_f32_bf16 v75, v53, v53
    v_dot2c_f32_bf16 v67, v54, v23
    v_dot2c_f32_bf16 v75, v54, v54
    v_dot2c_f32_bf16 v67, v55, v23
    v_dot2c_f32_bf16 v75, v55, v55
    v_permlane32_swap_b32 v60, v64
    v_permlane32_swap_b32 v61, v65
    v_permlane32_swap_b32 v62, v66
    v_permlane32_swap_b32 v63, v67
    v_add_f32 v60, v60, v64
    v_add_f32 v61, v61, v65
    v_add_f32 v62, v62, v66
    v_add_f32 v63, v63, v67
    v_permlane32_swap_b32 v68, v72
    v_permlane32_swap_b32 v69, v73
    v_permlane32_swap_b32 v70, v74
    v_permlane32_swap_b32 v71, v75
    v_add_f32 v68, v68, v72
    v_add_f32 v69, v69, v73
    v_add_f32 v70, v70, v74
    v_add_f32 v71, v71, v75
    v_permlane16_swap_b32 v60, v62
    v_permlane16_swap_b32 v61, v63
    v_add_f32 v60, v60, v62
    v_add_f32 v61, v61, v63
    v_permlane16_swap_b32 v68, v70
    v_permlane16_swap_b32 v69, v71
    v_add_f32 v68, v68, v70
    v_add_f32 v69, v69, v71
    v_add_f32_dpp v60, v60, v60 row_ror:1 row_mask:0xf bank_mask:0xf
    v_add_f32_dpp v61, v61, v61 row_ror:1 row_mask:0xf bank_mask:0xf
    v_add_f32_dpp v68, v68, v68 row_ror:1 row_mask:0xf bank_mask:0xf
    v_add_f32_dpp v69, v69, v69 row_ror:1 row_mask:0xf bank_mask:0xf
    v_add_f32_dpp v60, v60, v60 row_ror:2 row_mask:0xf bank_mask:0xf
    v_add_f32_dpp v61, v61, v61 row_ror:2 row_mask:0xf bank_mask:0xf
    v_add_f32_dpp v68, v68, v68 row_ror:2 row_mask:0xf bank_mask:0xf
    v_add_f32_dpp v69, v69, v69 row_ror:2 row_mask:0xf bank_mask:0xf
    v_add_f32_dpp v60, v60, v60 row_ror:4 row_mask:0xf bank_mask:0xf
    v_add_f32_dpp v61, v61, v61 row_ror:4 row_mask:0xf bank_mask:0xf
    v_add_f32_dpp v68, v68, v68 row_ror:4 row_mask:0xf bank_mask:0xf
    v_add_f32_dpp v69, v69, v69 row_ror:4 row_mask:0xf bank_mask:0xf
    v_add_f32_dpp v60, v60, v60 row_ror:8 row_mask:0xf bank_mask:0xf
    v_add_f32_dpp v61, v61, v61 row_ror:8 row_mask:0xf bank_mask:0xf
    v_add_f32_dpp v68, v68, v68 row_ror:8 row_mask:0xf bank_mask:0xf
    v_add_f32_dpp v69, v69, v69 row_ror:8 row_mask:0xf bank_mask:0xf
    v_mul_f32 v60, 0x3b000000, v60
    v_mul_f32 v68, 0x3b000000, v68
    v_fma_f32 v68, -v60, v60, v68
    v_max_f32 v68, 0, v68
    v_add_f32 v68, 0x3727c5ac, v68
    v_rsq_f32 v72, v68
    v_mov_b32 v73, s4
    v_mov_b32 v75, s4
    v_mul_f32 v74, v60, v72
    v_mul_f32 v61, 0x3b000000, v61
    v_mul_f32 v69, 0x3b000000, v69
    v_fma_f32 v69, -v61, v61, v69
    v_max_f32 v69, 0, v69
    v_add_f32 v69, 0x3727c5ac, v69
    v_rsq_f32 v76, v69
    v_mov_b32 v77, s4
    v_mov_b32 v79, s4
    v_mul_f32 v78, v61, v76
    s_lshl_b32 s80, s2, 7
    s_add_u32 s80, s80, 8192
    v_lshlrev_b32 v21, 5, v3
    s_mov_b64 s[98:99], exec
    s_mov_b32 exec_lo, 0x10001
    s_mov_b32 exec_hi, 0x10001
    buffer_store_dwordx4 v[72:75], v21, s[12:15], s80 offen sc1
    buffer_store_dwordx4 v[76:79], v21, s[12:15], s80 offen offset:16 sc1
    s_mov_b64 exec, s[98:99]
    s_branch L_A_join
L_role56:
    s_cmp_ge_u32 s2, 192
    s_cbranch_scc1 L_nomod_1
    s_mul_i32 s80, s7, 43
    s_lshr_b32 s80, s80, 8
    s_mul_i32 s81, s80, 6
    s_sub_u32 s81, s7, s81
    s_lshl_b32 s81, s81, 3
    s_add_u32 s89, s81, s6
    s_lshl_b32 s80, s80, 1
    s_add_u32 s80, s80, s5
    s_sub_u32 s79, s80, 5
    v_lshlrev_b32 v22, 1, v1
    s_lshl_b32 s80, s79, 7
    buffer_load_ushort v24, v22, s[52:55], s80 offen
    v_lshrrev_b32 v21, 3, v1
    v_mul_u32_u24 v23, 6144, v21
    v_and_b32 v40, 7, v1
    v_lshl_add_u32 v23, v40, 4, v23
    s_mul_i32 s80, s79, 393216
    s_lshl_b32 s81, s89, 7
    s_add_u32 s80, s80, s81
    buffer_load_dwordx4 v[64:67], v23, s[56:59], s80 offen
    s_add_u32 s80, s80, 49152
    buffer_load_dwordx4 v[68:71], v23, s[56:59], s80 offen
    s_add_u32 s80, s80, 49152
    buffer_load_dwordx4 v[72:75], v23, s[56:59], s80 offen
    s_add_u32 s80, s80, 49152
    buffer_load_dwordx4 v[76:79], v23, s[56:59], s80 offen
    s_add_u32 s80, s80, 49152
    buffer_load_dwordx4 v[80:83], v23, s[56:59], s80 offen
    s_add_u32 s80, s80, 49152
    buffer_load_dwordx4 v[84:87], v23, s[56:59], s80 offen
    s_add_u32 s80, s80, 49152
    buffer_load_dwordx4 v[88:91], v23, s[56:59], s80 offen
    s_add_u32 s80, s80, 49152
    buffer_load_dwordx4 v[92:95], v23, s[56:59], s80 offen
    s_load_dword s4, s[12:13], 0
    v_lshlrev_b32 v5, 4, v2
    v_lshl_add_u32 v5, v3, 9, v5
    v_and_b32 v16, 255, v0
    v_lshlrev_b32 v16, 3, v16
    s_lshr_b32 s80, s5, 2
    s_mul_i32 s80, s80, 5120
    s_add_u32 s80, s80, 69632
    v_cvt_f32_u32 v17, s80
    s_add_u32 s80, s80, 5118
    v_mov_b32 v18, s80
    v_cvt_f32_u32 v19, v16
    v_cmp_eq_u32 vcc, 0, v16
    v_add_f32 v20, 0xc0400000, v19
    v_cvt_pk_bf16_f32 v20, v20, v20
    v_and_b32 v20, 0xffff0000, v20
    v_fma_f32 v20, v20, 2.0, v17
    v_cvt_u32_f32 v113, v20
    v_cndmask_b32 v113, v113, v18, vcc
    v_add_f32 v20, -2.0, v19
    v_cvt_pk_bf16_f32 v20, v20, v20
    v_and_b32 v20, 0xffff0000, v20
    v_fma_f32 v20, v20, 2.0, v17
    v_cvt_u32_f32 v114, v20
    v_cndmask_b32 v114, v114, v18, vcc
    v_add_f32 v20, -1.0, v19
    v_cvt_pk_bf16_f32 v20, v20, v20
    v_and_b32 v20, 0xffff0000, v20
    v_fma_f32 v20, v20, 2.0, v17
    v_cvt_u32_f32 v115, v20
    v_cndmask_b32 v115, v115, v18, vcc
    v_add_f32 v20, 0x0, v19
    v_cvt_pk_bf16_f32 v20, v20, v20
    v_and_b32 v20, 0xffff0000, v20
    v_fma_f32 v20, v20, 2.0, v17
    v_cvt_u32_f32 v116, v20
    v_add_f32 v20, 1.0, v19
    v_cvt_pk_bf16_f32 v20, v20, v20
    v_and_b32 v20, 0xffff0000, v20
    v_fma_f32 v20, v20, 2.0, v17
    v_cvt_u32_f32 v117, v20
    v_add_f32 v20, 2.0, v19
    v_cvt_pk_bf16_f32 v20, v20, v20
    v_and_b32 v20, 0xffff0000, v20
    v_fma_f32 v20, v20, 2.0, v17
    v_cvt_u32_f32 v118, v20
    v_add_f32 v20, 0x40400000, v19
    v_cvt_pk_bf16_f32 v20, v20, v20
    v_and_b32 v20, 0xffff0000, v20
    v_fma_f32 v20, v20, 2.0, v17
    v_cvt_u32_f32 v119, v20
    v_add_f32 v20, 4.0, v19
    v_cvt_pk_bf16_f32 v20, v20, v20
    v_and_b32 v20, 0xffff0000, v20
    v_fma_f32 v20, v20, 2.0, v17
    v_cvt_u32_f32 v120, v20
    v_add_f32 v20, 0x40a00000, v19
    v_cvt_pk_bf16_f32 v20, v20, v20
    v_and_b32 v20, 0xffff0000, v20
    v_fma_f32 v20, v20, 2.0, v17
    v_cvt_u32_f32 v121, v20
    v_add_f32 v20, 0x40c00000, v19
    v_cvt_pk_bf16_f32 v20, v20, v20
    v_and_b32 v20, 0xffff0000, v20
    v_fma_f32 v20, v20, 2.0, v17
    v_cvt_u32_f32 v122, v20
    v_add_f32 v20, 0x40e00000, v19
    v_cvt_pk_bf16_f32 v20, v20, v20
    v_and_b32 v20, 0xffff0000, v20
    v_fma_f32 v20, v20, 2.0, v17
    v_cvt_u32_f32 v123, v20
    s_cmp_ge_u32 s5, 3
    s_cselect_b32 s80, 1, 0
    s_mul_i32 s81, s80, 3
    s_sub_u32 s81, s5, s81
    s_mul_i32 s82, s80, 26112
    s_mul_i32 s83, s81, 8704
    s_add_u32 s82, s82, s83
    v_mul_u32_u24 v16, 544, v2
    v_lshl_add_u32 v16, v3, 4, v16
    v_add_u32 v108, s82, v16
    s_mul_i32 s82, s80, 8704
    s_add_u32 s82, s82, 52224
    v_add_u32 v109, s82, v16
    s_mov_b32 s82, 262144
    s_cmp_eq_u32 s81, 1
    s_cselect_b32 s82, 25166080, s82
    s_cmp_eq_u32 s81, 2
    s_cselect_b32 s82, 100664320, s82
    s_mov_b32 s83, 8650880
    s_cmp_eq_u32 s81, 1
    s_cselect_b32 s83, 33817088, s83
    s_cmp_eq_u32 s81, 2
    s_cselect_b32 s83, 134285312, s83
    s_mov_b32 s87, 16843009
    s_cmp_eq_u32 s81, 1
    s_cselect_b32 s87, 2155872770, s87
    s_cmp_eq_u32 s81, 2
    s_cselect_b32 s87, 2155905152, s87
    v_cmp_gt_u32 vcc, 2, v3
    v_mov_b32 v16, s83
    v_mov_b32 v17, s82
    v_cndmask_b32 v16, v16, v17, vcc
    v_and_b32 v17, 1, v3
    v_lshlrev_b32 v17, 4, v17
    v_bfe_u32 v16, v16, v17, 16
    v_lshlrev_b32 v17, 3, v3
    v_bfe_u32 v17, s87, v17, 8
    v_lshl_add_u32 v16, v2, 3, v16
    s_mul_i32 s82, s80, 5120
    s_add_u32 s82, s82, 69632
    v_lshlrev_b32 v16, 1, v16
    v_add_u32 v104, s82, v16
    v_lshlrev_b32 v17, 1, v17
    v_add_u32 v105, v104, v17
    v_add_u32 v106, v105, v17
    v_add_u32 v107, v106, v17
    s_lshl_b32 s80, s5, 12
    v_add_u32 v9, s80, v4
    v_lshrrev_b32 v16, 3, v1
    v_cmp_gt_u32 vcc, 6, v16
    v_mov_b32 v17, 0
    s_nop 0
    v_cndmask_b32 v16, v17, v16, vcc
    v_lshrrev_b32 v17, 1, v16
    v_lshlrev_b32 v17, 9, v17
    v_and_b32 v16, 1, v16
    v_add_u32 v17, v17, v16
    v_add_u32 v17, s76, v17
    v_and_b32 v16, 7, v1
    v_mul_u32_u24 v16, 3072, v16
    v_add_u32 v17, v17, v16
    v_lshlrev_b32 v10, 3, v17
    s_lshr_b32 s82, s5, 2
    s_and_b32 s83, s5, 3
    s_mul_i32 s80, s82, 4672
    s_lshl_b32 s81, s83, 6
    s_sub_u32 s80, s80, s81
    s_add_u32 s80, s80, 151776
    v_lshlrev_b32 v6, 5, v2
    v_lshl_add_u32 v6, v3, 4, v6
    v_add_u32 v6, s80, v6
    s_mul_i32 s80, s82, 16640
    s_add_u32 s80, s80, s81
    s_add_u32 s80, s80, 79928
    v_lshrrev_b32 v7, 2, v2
    v_mul_u32_u24 v7, 4160, v7
    v_and_b32 v16, 3, v2
    v_lshl_add_u32 v7, v16, 3, v7
    v_lshlrev_b32 v16, 4, v3
    v_sub_u32 v7, v7, v16
    v_add_u32 v7, s80, v7
    s_lshl_b32 s80, s5, 13
    v_add_u32 v8, s80, v4
    v_lshlrev_b32 v16, 4, v2
    v_lshl_add_u32 v16, v3, 2, v16
    s_lshl_b32 s80, s5, 8
    v_add_u32 v16, s80, v16
    v_lshlrev_b32 v11, 2, v16
    v_add_u32 v11, 143360, v11
    v_lshlrev_b32 v12, 1, v16
    v_add_u32 v12, 152064, v12
    v_lshrrev_b32 v13, 1, v2
    v_lshlrev_b32 v13, 15, v13
    v_and_b32 v16, 1, v2
    v_lshl_add_u32 v13, v16, 5, v13
    v_and_b32 v16, 1, v3
    v_lshl_add_u32 v13, v16, 6, v13
    v_lshrrev_b32 v16, 1, v3
    v_lshl_add_u32 v13, v16, 4, v13
    s_waitcnt lgkmcnt(0)
    s_add_u32 s4, s4, 1
    s_waitcnt vmcnt(8)
    v_lshlrev_b32 v24, 16, v24
    v_mul_f32 v58, 0xbfb8aa3b, v24
    v_exp_f32 v58, v58
    s_nop 0
    v_add_f32 v58, 1.0, v58
    v_rcp_f32 v58, v58
    s_nop 0
    v_mul_f32 v58, v58, v24
    v_cvt_pk_bf16_f32 v58, v58, v58
    v_and_b32 v56, 0xffff, v58
    v_and_b32 v57, 0xffff0000, v58
    s_sub_u32 s80, s5, 5
    s_lshl_b32 s80, s80, 9
    s_add_u32 s80, s80, 139264
    v_and_b32 v25, 7, v1
    v_lshlrev_b32 v25, 5, v25
    v_lshrrev_b32 v26, 3, v1
    v_lshl_add_u32 v25, v26, 2, v25
    v_add_u32 v25, s80, v25
    ds_write_b32 v25, v56
    ds_write_b32 v25, v57 offset:256
    v_lshl_add_u32 v25, v21, 5, s80
    s_waitcnt lgkmcnt(0)
    ds_read_b128 v[28:31], v25
    ds_read_b128 v[32:35], v25 offset:16
    ds_read_b128 v[40:43], v25 offset:256
    ds_read_b128 v[44:47], v25 offset:272
    s_waitcnt lgkmcnt(0)
    s_waitcnt vmcnt(7)
    v_dot2_f32_bf16 v48, v64, v28, 0
    v_dot2_f32_bf16 v49, v64, v40, 0
    v_dot2_f32_bf16 v50, v65, v28, 0
    v_dot2_f32_bf16 v51, v65, v40, 0
    v_dot2_f32_bf16 v52, v66, v28, 0
    v_dot2_f32_bf16 v53, v66, v40, 0
    v_dot2_f32_bf16 v54, v67, v28, 0
    v_dot2_f32_bf16 v55, v67, v40, 0
    s_waitcnt vmcnt(6)
    v_dot2c_f32_bf16 v48, v68, v29
    v_dot2c_f32_bf16 v49, v68, v41
    v_dot2c_f32_bf16 v50, v69, v29
    v_dot2c_f32_bf16 v51, v69, v41
    v_dot2c_f32_bf16 v52, v70, v29
    v_dot2c_f32_bf16 v53, v70, v41
    v_dot2c_f32_bf16 v54, v71, v29
    v_dot2c_f32_bf16 v55, v71, v41
    s_waitcnt vmcnt(5)
    v_dot2c_f32_bf16 v48, v72, v30
    v_dot2c_f32_bf16 v49, v72, v42
    v_dot2c_f32_bf16 v50, v73, v30
    v_dot2c_f32_bf16 v51, v73, v42
    v_dot2c_f32_bf16 v52, v74, v30
    v_dot2c_f32_bf16 v53, v74, v42
    v_dot2c_f32_bf16 v54, v75, v30
    v_dot2c_f32_bf16 v55, v75, v42
    s_waitcnt vmcnt(4)
    v_dot2c_f32_bf16 v48, v76, v31
    v_dot2c_f32_bf16 v49, v76, v43
    v_dot2c_f32_bf16 v50, v77, v31
    v_dot2c_f32_bf16 v51, v77, v43
    v_dot2c_f32_bf16 v52, v78, v31
    v_dot2c_f32_bf16 v53, v78, v43
    v_dot2c_f32_bf16 v54, v79, v31
    v_dot2c_f32_bf16 v55, v79, v43
    s_waitcnt vmcnt(3)
    v_dot2c_f32_bf16 v48, v80, v32
    v_dot2c_f32_bf16 v49, v80, v44
    v_dot2c_f32_bf16 v50, v81, v32
    v_dot2c_f32_bf16 v51, v81, v44
    v_dot2c_f32_bf16 v52, v82, v32
    v_dot2c_f32_bf16 v53, v82, v44
    v_dot2c_f32_bf16 v54, v83, v32
    v_dot2c_f32_bf16 v55, v83, v44
    s_waitcnt vmcnt(2)
    v_dot2c_f32_bf16 v48, v84, v33
    v_dot2c_f32_bf16 v49, v84, v45
    v_dot2c_f32_bf16 v50, v85, v33
    v_dot2c_f32_bf16 v51, v85, v45
    v_dot2c_f32_bf16 v52, v86, v33
    v_dot2c_f32_bf16 v53, v86, v45
    v_dot2c_f32_bf16 v54, v87, v33
    v_dot2c_f32_bf16 v55, v87, v45
    s_waitcnt vmcnt(1)
    v_dot2c_f32_bf16 v48, v88, v34
    v_dot2c_f32_bf16 v49, v88, v46
    v_dot2c_f32_bf16 v50, v89, v34
    v_dot2c_f32_bf16 v51, v89, v46
    v_dot2c_f32_bf16 v52, v90, v34
    v_dot2c_f32_bf16 v53, v90, v46
    v_dot2c_f32_bf16 v54, v91, v34
    v_dot2c_f32_bf16 v55, v91, v46
    s_waitcnt vmcnt(0)
    v_dot2c_f32_bf16 v48, v92, v35
    v_dot2c_f32_bf16 v49, v92, v47
    v_dot2c_f32_bf16 v50, v93, v35
    v_dot2c_f32_bf16 v51, v93, v47
    v_dot2c_f32_bf16 v52, v94, v35
    v_dot2c_f32_bf16 v53, v94, v47
    v_dot2c_f32_bf16 v54, v95, v35
    v_dot2c_f32_bf16 v55, v95, v47
    v_permlane32_swap_b32 v48, v52
    v_permlane32_swap_b32 v49, v53
    v_permlane32_swap_b32 v50, v54
    v_permlane32_swap_b32 v51, v55
    v_add_f32 v48, v48, v52
    v_add_f32 v49, v49, v53
    v_add_f32 v50, v50, v54
    v_add_f32 v51, v51, v55
    s_nop 0
    v_permlane16_swap_b32 v48, v50
    v_permlane16_swap_b32 v49, v51
    v_add_f32 v48, v48, v50
    v_add_f32 v49, v49, v51
    s_nop 0
    v_add_f32_dpp v48, v48, v48 row_ror:8 row_mask:0xf bank_mask:0xf
    v_add_f32_dpp v49, v49, v49 row_ror:8 row_mask:0xf bank_mask:0xf
    v_and_b32 v21, 1, v3
    v_lshlrev_b32 v21, 1, v21
    v_lshrrev_b32 v22, 1, v3
    v_lshl_add_u32 v21, v22, 2, v21
    v_and_b32 v22, 7, v1
    v_lshl_add_u32 v21, v22, 3, v21
    v_lshlrev_b32 v21, 3, v21
    s_mul_i32 s80, s79, 3072
    s_lshl_b32 s81, s89, 6
    s_add_u32 s80, s80, s81
    s_lshl_b32 s80, s80, 3
    s_add_u32 s80, s80, 40960
    v_mov_b32 v50, v49
    v_mov_b32 v49, s4
    v_mov_b32 v51, s4
    s_mov_b64 s[98:99], exec
    s_mov_b32 exec_lo, 0xff00ff
    s_mov_b32 exec_hi, 0xff00ff
    buffer_store_dwordx4 v[48:51], v21, s[12:15], s80 offen sc1
    s_mov_b64 exec, s[98:99]
    s_branch L_moddone_2
L_nomod_1:
    s_load_dword s4, s[12:13], 0
    v_lshlrev_b32 v5, 4, v2
    v_lshl_add_u32 v5, v3, 9, v5
    v_and_b32 v16, 255, v0
    v_lshlrev_b32 v16, 3, v16
    s_lshr_b32 s80, s5, 2
    s_mul_i32 s80, s80, 5120
    s_add_u32 s80, s80, 69632
    v_cvt_f32_u32 v17, s80
    s_add_u32 s80, s80, 5118
    v_mov_b32 v18, s80
    v_cvt_f32_u32 v19, v16
    v_cmp_eq_u32 vcc, 0, v16
    v_add_f32 v20, 0xc0400000, v19
    v_cvt_pk_bf16_f32 v20, v20, v20
    v_and_b32 v20, 0xffff0000, v20
    v_fma_f32 v20, v20, 2.0, v17
    v_cvt_u32_f32 v113, v20
    v_cndmask_b32 v113, v113, v18, vcc
    v_add_f32 v20, -2.0, v19
    v_cvt_pk_bf16_f32 v20, v20, v20
    v_and_b32 v20, 0xffff0000, v20
    v_fma_f32 v20, v20, 2.0, v17
    v_cvt_u32_f32 v114, v20
    v_cndmask_b32 v114, v114, v18, vcc
    v_add_f32 v20, -1.0, v19
    v_cvt_pk_bf16_f32 v20, v20, v20
    v_and_b32 v20, 0xffff0000, v20
    v_fma_f32 v20, v20, 2.0, v17
    v_cvt_u32_f32 v115, v20
    v_cndmask_b32 v115, v115, v18, vcc
    v_add_f32 v20, 0x0, v19
    v_cvt_pk_bf16_f32 v20, v20, v20
    v_and_b32 v20, 0xffff0000, v20
    v_fma_f32 v20, v20, 2.0, v17
    v_cvt_u32_f32 v116, v20
    v_add_f32 v20, 1.0, v19
    v_cvt_pk_bf16_f32 v20, v20, v20
    v_and_b32 v20, 0xffff0000, v20
    v_fma_f32 v20, v20, 2.0, v17
    v_cvt_u32_f32 v117, v20
    v_add_f32 v20, 2.0, v19
    v_cvt_pk_bf16_f32 v20, v20, v20
    v_and_b32 v20, 0xffff0000, v20
    v_fma_f32 v20, v20, 2.0, v17
    v_cvt_u32_f32 v118, v20
    v_add_f32 v20, 0x40400000, v19
    v_cvt_pk_bf16_f32 v20, v20, v20
    v_and_b32 v20, 0xffff0000, v20
    v_fma_f32 v20, v20, 2.0, v17
    v_cvt_u32_f32 v119, v20
    v_add_f32 v20, 4.0, v19
    v_cvt_pk_bf16_f32 v20, v20, v20
    v_and_b32 v20, 0xffff0000, v20
    v_fma_f32 v20, v20, 2.0, v17
    v_cvt_u32_f32 v120, v20
    v_add_f32 v20, 0x40a00000, v19
    v_cvt_pk_bf16_f32 v20, v20, v20
    v_and_b32 v20, 0xffff0000, v20
    v_fma_f32 v20, v20, 2.0, v17
    v_cvt_u32_f32 v121, v20
    v_add_f32 v20, 0x40c00000, v19
    v_cvt_pk_bf16_f32 v20, v20, v20
    v_and_b32 v20, 0xffff0000, v20
    v_fma_f32 v20, v20, 2.0, v17
    v_cvt_u32_f32 v122, v20
    v_add_f32 v20, 0x40e00000, v19
    v_cvt_pk_bf16_f32 v20, v20, v20
    v_and_b32 v20, 0xffff0000, v20
    v_fma_f32 v20, v20, 2.0, v17
    v_cvt_u32_f32 v123, v20
    s_cmp_ge_u32 s5, 3
    s_cselect_b32 s80, 1, 0
    s_mul_i32 s81, s80, 3
    s_sub_u32 s81, s5, s81
    s_mul_i32 s82, s80, 26112
    s_mul_i32 s83, s81, 8704
    s_add_u32 s82, s82, s83
    v_mul_u32_u24 v16, 544, v2
    v_lshl_add_u32 v16, v3, 4, v16
    v_add_u32 v108, s82, v16
    s_mul_i32 s82, s80, 8704
    s_add_u32 s82, s82, 52224
    v_add_u32 v109, s82, v16
    s_mov_b32 s82, 262144
    s_cmp_eq_u32 s81, 1
    s_cselect_b32 s82, 25166080, s82
    s_cmp_eq_u32 s81, 2
    s_cselect_b32 s82, 100664320, s82
    s_mov_b32 s83, 8650880
    s_cmp_eq_u32 s81, 1
    s_cselect_b32 s83, 33817088, s83
    s_cmp_eq_u32 s81, 2
    s_cselect_b32 s83, 134285312, s83
    s_mov_b32 s87, 16843009
    s_cmp_eq_u32 s81, 1
    s_cselect_b32 s87, 2155872770, s87
    s_cmp_eq_u32 s81, 2
    s_cselect_b32 s87, 2155905152, s87
    v_cmp_gt_u32 vcc, 2, v3
    v_mov_b32 v16, s83
    v_mov_b32 v17, s82
    v_cndmask_b32 v16, v16, v17, vcc
    v_and_b32 v17, 1, v3
    v_lshlrev_b32 v17, 4, v17
    v_bfe_u32 v16, v16, v17, 16
    v_lshlrev_b32 v17, 3, v3
    v_bfe_u32 v17, s87, v17, 8
    v_lshl_add_u32 v16, v2, 3, v16
    s_mul_i32 s82, s80, 5120
    s_add_u32 s82, s82, 69632
    v_lshlrev_b32 v16, 1, v16
    v_add_u32 v104, s82, v16
    v_lshlrev_b32 v17, 1, v17
    v_add_u32 v105, v104, v17
    v_add_u32 v106, v105, v17
    v_add_u32 v107, v106, v17
    s_lshl_b32 s80, s5, 12
    v_add_u32 v9, s80, v4
    v_lshrrev_b32 v16, 3, v1
    v_cmp_gt_u32 vcc, 6, v16
    v_mov_b32 v17, 0
    s_nop 0
    v_cndmask_b32 v16, v17, v16, vcc
    v_lshrrev_b32 v17, 1, v16
    v_lshlrev_b32 v17, 9, v17
    v_and_b32 v16, 1, v16
    v_add_u32 v17, v17, v16
    v_add_u32 v17, s76, v17
    v_and_b32 v16, 7, v1
    v_mul_u32_u24 v16, 3072, v16
    v_add_u32 v17, v17, v16
    v_lshlrev_b32 v10, 3, v17
    s_lshr_b32 s82, s5, 2
    s_and_b32 s83, s5, 3
    s_mul_i32 s80, s82, 4672
    s_lshl_b32 s81, s83, 6
    s_sub_u32 s80, s80, s81
    s_add_u32 s80, s80, 151776
    v_lshlrev_b32 v6, 5, v2
    v_lshl_add_u32 v6, v3, 4, v6
    v_add_u32 v6, s80, v6
    s_mul_i32 s80, s82, 16640
    s_add_u32 s80, s80, s81
    s_add_u32 s80, s80, 79928
    v_lshrrev_b32 v7, 2, v2
    v_mul_u32_u24 v7, 4160, v7
    v_and_b32 v16, 3, v2
    v_lshl_add_u32 v7, v16, 3, v7
    v_lshlrev_b32 v16, 4, v3
    v_sub_u32 v7, v7, v16
    v_add_u32 v7, s80, v7
    s_lshl_b32 s80, s5, 13
    v_add_u32 v8, s80, v4
    v_lshlrev_b32 v16, 4, v2
    v_lshl_add_u32 v16, v3, 2, v16
    s_lshl_b32 s80, s5, 8
    v_add_u32 v16, s80, v16
    v_lshlrev_b32 v11, 2, v16
    v_add_u32 v11, 143360, v11
    v_lshlrev_b32 v12, 1, v16
    v_add_u32 v12, 152064, v12
    v_lshrrev_b32 v13, 1, v2
    v_lshlrev_b32 v13, 15, v13
    v_and_b32 v16, 1, v2
    v_lshl_add_u32 v13, v16, 5, v13
    v_and_b32 v16, 1, v3
    v_lshl_add_u32 v13, v16, 6, v13
    v_lshrrev_b32 v16, 1, v3
    v_lshl_add_u32 v13, v16, 4, v13
    s_waitcnt lgkmcnt(0)
    s_add_u32 s4, s4, 1
L_moddone_2:
    s_branch L_A_join
L_role7:
    v_lshlrev_b32 v21, 10, v1
    s_lshl_b32 s80, s7, 16
    s_lshl_b32 s81, s6, 7
    s_add_u32 s80, s80, s81
    buffer_load_dwordx4 v[24:27], v21, s[8:11], s80 offen
    buffer_load_dwordx4 v[28:31], v21, s[8:11], s80 offen offset:16
    buffer_load_dwordx4 v[32:35], v21, s[8:11], s80 offen offset:32
    buffer_load_dwordx4 v[36:39], v21, s[8:11], s80 offen offset:48
    buffer_load_dwordx4 v[40:43], v21, s[8:11], s80 offen offset:64
    buffer_load_dwordx4 v[44:47], v21, s[8:11], s80 offen offset:80
    buffer_load_dwordx4 v[48:51], v21, s[8:11], s80 offen offset:96
    buffer_load_dwordx4 v[52:55], v21, s[8:11], s80 offen offset:112
    s_load_dword s4, s[12:13], 0
    v_lshlrev_b32 v5, 4, v2
    v_lshl_add_u32 v5, v3, 9, v5
    v_and_b32 v16, 255, v0
    v_lshlrev_b32 v16, 3, v16
    s_lshr_b32 s80, s5, 2
    s_mul_i32 s80, s80, 5120
    s_add_u32 s80, s80, 69632
    v_cvt_f32_u32 v17, s80
    s_add_u32 s80, s80, 5118
    v_mov_b32 v18, s80
    v_cvt_f32_u32 v19, v16
    v_cmp_eq_u32 vcc, 0, v16
    v_add_f32 v20, 0xc0400000, v19
    v_cvt_pk_bf16_f32 v20, v20, v20
    v_and_b32 v20, 0xffff0000, v20
    v_fma_f32 v20, v20, 2.0, v17
    v_cvt_u32_f32 v113, v20
    v_cndmask_b32 v113, v113, v18, vcc
    v_add_f32 v20, -2.0, v19
    v_cvt_pk_bf16_f32 v20, v20, v20
    v_and_b32 v20, 0xffff0000, v20
    v_fma_f32 v20, v20, 2.0, v17
    v_cvt_u32_f32 v114, v20
    v_cndmask_b32 v114, v114, v18, vcc
    v_add_f32 v20, -1.0, v19
    v_cvt_pk_bf16_f32 v20, v20, v20
    v_and_b32 v20, 0xffff0000, v20
    v_fma_f32 v20, v20, 2.0, v17
    v_cvt_u32_f32 v115, v20
    v_cndmask_b32 v115, v115, v18, vcc
    v_add_f32 v20, 0x0, v19
    v_cvt_pk_bf16_f32 v20, v20, v20
    v_and_b32 v20, 0xffff0000, v20
    v_fma_f32 v20, v20, 2.0, v17
    v_cvt_u32_f32 v116, v20
    v_add_f32 v20, 1.0, v19
    v_cvt_pk_bf16_f32 v20, v20, v20
    v_and_b32 v20, 0xffff0000, v20
    v_fma_f32 v20, v20, 2.0, v17
    v_cvt_u32_f32 v117, v20
    v_add_f32 v20, 2.0, v19
    v_cvt_pk_bf16_f32 v20, v20, v20
    v_and_b32 v20, 0xffff0000, v20
    v_fma_f32 v20, v20, 2.0, v17
    v_cvt_u32_f32 v118, v20
    v_add_f32 v20, 0x40400000, v19
    v_cvt_pk_bf16_f32 v20, v20, v20
    v_and_b32 v20, 0xffff0000, v20
    v_fma_f32 v20, v20, 2.0, v17
    v_cvt_u32_f32 v119, v20
    v_add_f32 v20, 4.0, v19
    v_cvt_pk_bf16_f32 v20, v20, v20
    v_and_b32 v20, 0xffff0000, v20
    v_fma_f32 v20, v20, 2.0, v17
    v_cvt_u32_f32 v120, v20
    v_add_f32 v20, 0x40a00000, v19
    v_cvt_pk_bf16_f32 v20, v20, v20
    v_and_b32 v20, 0xffff0000, v20
    v_fma_f32 v20, v20, 2.0, v17
    v_cvt_u32_f32 v121, v20
    v_add_f32 v20, 0x40c00000, v19
    v_cvt_pk_bf16_f32 v20, v20, v20
    v_and_b32 v20, 0xffff0000, v20
    v_fma_f32 v20, v20, 2.0, v17
    v_cvt_u32_f32 v122, v20
    v_add_f32 v20, 0x40e00000, v19
    v_cvt_pk_bf16_f32 v20, v20, v20
    v_and_b32 v20, 0xffff0000, v20
    v_fma_f32 v20, v20, 2.0, v17
    v_cvt_u32_f32 v123, v20
    s_cmp_ge_u32 s5, 3
    s_cselect_b32 s80, 1, 0
    s_mul_i32 s81, s80, 3
    s_sub_u32 s81, s5, s81
    s_mul_i32 s82, s80, 26112
    s_mul_i32 s83, s81, 8704
    s_add_u32 s82, s82, s83
    v_mul_u32_u24 v16, 544, v2
    v_lshl_add_u32 v16, v3, 4, v16
    v_add_u32 v108, s82, v16
    s_mul_i32 s82, s80, 8704
    s_add_u32 s82, s82, 52224
    v_add_u32 v109, s82, v16
    s_mov_b32 s82, 262144
    s_cmp_eq_u32 s81, 1
    s_cselect_b32 s82, 25166080, s82
    s_cmp_eq_u32 s81, 2
    s_cselect_b32 s82, 100664320, s82
    s_mov_b32 s83, 8650880
    s_cmp_eq_u32 s81, 1
    s_cselect_b32 s83, 33817088, s83
    s_cmp_eq_u32 s81, 2
    s_cselect_b32 s83, 134285312, s83
    s_mov_b32 s87, 16843009
    s_cmp_eq_u32 s81, 1
    s_cselect_b32 s87, 2155872770, s87
    s_cmp_eq_u32 s81, 2
    s_cselect_b32 s87, 2155905152, s87
    v_cmp_gt_u32 vcc, 2, v3
    v_mov_b32 v16, s83
    v_mov_b32 v17, s82
    v_cndmask_b32 v16, v16, v17, vcc
    v_and_b32 v17, 1, v3
    v_lshlrev_b32 v17, 4, v17
    v_bfe_u32 v16, v16, v17, 16
    v_lshlrev_b32 v17, 3, v3
    v_bfe_u32 v17, s87, v17, 8
    v_lshl_add_u32 v16, v2, 3, v16
    s_mul_i32 s82, s80, 5120
    s_add_u32 s82, s82, 69632
    v_lshlrev_b32 v16, 1, v16
    v_add_u32 v104, s82, v16
    v_lshlrev_b32 v17, 1, v17
    v_add_u32 v105, v104, v17
    v_add_u32 v106, v105, v17
    v_add_u32 v107, v106, v17
    s_lshl_b32 s80, s5, 12
    v_add_u32 v9, s80, v4
    v_lshrrev_b32 v16, 3, v1
    v_cmp_gt_u32 vcc, 6, v16
    v_mov_b32 v17, 0
    s_nop 0
    v_cndmask_b32 v16, v17, v16, vcc
    v_lshrrev_b32 v17, 1, v16
    v_lshlrev_b32 v17, 9, v17
    v_and_b32 v16, 1, v16
    v_add_u32 v17, v17, v16
    v_add_u32 v17, s76, v17
    v_and_b32 v16, 7, v1
    v_mul_u32_u24 v16, 3072, v16
    v_add_u32 v17, v17, v16
    v_lshlrev_b32 v10, 3, v17
    s_lshr_b32 s82, s5, 2
    s_and_b32 s83, s5, 3
    s_mul_i32 s80, s82, 4672
    s_lshl_b32 s81, s83, 6
    s_sub_u32 s80, s80, s81
    s_add_u32 s80, s80, 151776
    v_lshlrev_b32 v6, 5, v2
    v_lshl_add_u32 v6, v3, 4, v6
    v_add_u32 v6, s80, v6
    s_mul_i32 s80, s82, 16640
    s_add_u32 s80, s80, s81
    s_add_u32 s80, s80, 79928
    v_lshrrev_b32 v7, 2, v2
    v_mul_u32_u24 v7, 4160, v7
    v_and_b32 v16, 3, v2
    v_lshl_add_u32 v7, v16, 3, v7
    v_lshlrev_b32 v16, 4, v3
    v_sub_u32 v7, v7, v16
    v_add_u32 v7, s80, v7
    s_lshl_b32 s80, s5, 13
    v_add_u32 v8, s80, v4
    v_lshlrev_b32 v16, 4, v2
    v_lshl_add_u32 v16, v3, 2, v16
    s_lshl_b32 s80, s5, 8
    v_add_u32 v16, s80, v16
    v_lshlrev_b32 v11, 2, v16
    v_add_u32 v11, 143360, v11
    v_lshlrev_b32 v12, 1, v16
    v_add_u32 v12, 152064, v12
    v_lshrrev_b32 v13, 1, v2
    v_lshlrev_b32 v13, 15, v13
    v_and_b32 v16, 1, v2
    v_lshl_add_u32 v13, v16, 5, v13
    v_and_b32 v16, 1, v3
    v_lshl_add_u32 v13, v16, 6, v13
    v_lshrrev_b32 v16, 1, v3
    v_lshl_add_u32 v13, v16, 4, v13
    s_waitcnt lgkmcnt(0)
    s_add_u32 s4, s4, 1
    v_mov_b32 v57, s4
    v_mov_b32 v59, s4
    v_mov_b32 v61, s4
    v_mov_b32 v63, s4
    v_lshlrev_b32 v21, 3, v1
    s_lshl_b32 s80, s6, 19
    s_lshl_b32 s81, s7, 9
    s_add_u32 s80, s80, s81
    s_add_u32 s80, s80, 17235968
    s_waitcnt vmcnt(7)
    v_mov_b32 v56, v24
    buffer_store_dwordx2 v[56:57], v21, s[12:15], s80 offen sc1
    s_add_u32 s80, s80, 16384
    v_mov_b32 v58, v25
    buffer_store_dwordx2 v[58:59], v21, s[12:15], s80 offen sc1
    s_add_u32 s80, s80, 16384
    v_mov_b32 v60, v26
    buffer_store_dwordx2 v[60:61], v21, s[12:15], s80 offen sc1
    s_add_u32 s80, s80, 16384
    v_mov_b32 v62, v27
    buffer_store_dwordx2 v[62:63], v21, s[12:15], s80 offen sc1
    s_add_u32 s80, s80, 16384
    s_waitcnt vmcnt(10)
    v_mov_b32 v56, v28
    buffer_store_dwordx2 v[56:57], v21, s[12:15], s80 offen sc1
    s_add_u32 s80, s80, 16384
    v_mov_b32 v58, v29
    buffer_store_dwordx2 v[58:59], v21, s[12:15], s80 offen sc1
    s_add_u32 s80, s80, 16384
    v_mov_b32 v60, v30
    buffer_store_dwordx2 v[60:61], v21, s[12:15], s80 offen sc1
    s_add_u32 s80, s80, 16384
    v_mov_b32 v62, v31
    buffer_store_dwordx2 v[62:63], v21, s[12:15], s80 offen sc1
    s_add_u32 s80, s80, 16384
    s_waitcnt vmcnt(13)
    v_mov_b32 v56, v32
    buffer_store_dwordx2 v[56:57], v21, s[12:15], s80 offen sc1
    s_add_u32 s80, s80, 16384
    v_mov_b32 v58, v33
    buffer_store_dwordx2 v[58:59], v21, s[12:15], s80 offen sc1
    s_add_u32 s80, s80, 16384
    v_mov_b32 v60, v34
    buffer_store_dwordx2 v[60:61], v21, s[12:15], s80 offen sc1
    s_add_u32 s80, s80, 16384
    v_mov_b32 v62, v35
    buffer_store_dwordx2 v[62:63], v21, s[12:15], s80 offen sc1
    s_add_u32 s80, s80, 16384
    s_waitcnt vmcnt(16)
    v_mov_b32 v56, v36
    buffer_store_dwordx2 v[56:57], v21, s[12:15], s80 offen sc1
    s_add_u32 s80, s80, 16384
    v_mov_b32 v58, v37
    buffer_store_dwordx2 v[58:59], v21, s[12:15], s80 offen sc1
    s_add_u32 s80, s80, 16384
    v_mov_b32 v60, v38
    buffer_store_dwordx2 v[60:61], v21, s[12:15], s80 offen sc1
    s_add_u32 s80, s80, 16384
    v_mov_b32 v62, v39
    buffer_store_dwordx2 v[62:63], v21, s[12:15], s80 offen sc1
    s_add_u32 s80, s80, 16384
    s_waitcnt vmcnt(19)
    v_mov_b32 v56, v40
    buffer_store_dwordx2 v[56:57], v21, s[12:15], s80 offen sc1
    s_add_u32 s80, s80, 16384
    v_mov_b32 v58, v41
    buffer_store_dwordx2 v[58:59], v21, s[12:15], s80 offen sc1
    s_add_u32 s80, s80, 16384
    v_mov_b32 v60, v42
    buffer_store_dwordx2 v[60:61], v21, s[12:15], s80 offen sc1
    s_add_u32 s80, s80, 16384
    v_mov_b32 v62, v43
    buffer_store_dwordx2 v[62:63], v21, s[12:15], s80 offen sc1
    s_add_u32 s80, s80, 16384
    s_waitcnt vmcnt(22)
    v_mov_b32 v56, v44
    buffer_store_dwordx2 v[56:57], v21, s[12:15], s80 offen sc1
    s_add_u32 s80, s80, 16384
    v_mov_b32 v58, v45
    buffer_store_dwordx2 v[58:59], v21, s[12:15], s80 offen sc1
    s_add_u32 s80, s80, 16384
    v_mov_b32 v60, v46
    buffer_store_dwordx2 v[60:61], v21, s[12:15], s80 offen sc1
    s_add_u32 s80, s80, 16384
    v_mov_b32 v62, v47
    buffer_store_dwordx2 v[62:63], v21, s[12:15], s80 offen sc1
    s_add_u32 s80, s80, 16384
    s_waitcnt vmcnt(25)
    v_mov_b32 v56, v48
    buffer_store_dwordx2 v[56:57], v21, s[12:15], s80 offen sc1
    s_add_u32 s80, s80, 16384
    v_mov_b32 v58, v49
    buffer_store_dwordx2 v[58:59], v21, s[12:15], s80 offen sc1
    s_add_u32 s80, s80, 16384
    v_mov_b32 v60, v50
    buffer_store_dwordx2 v[60:61], v21, s[12:15], s80 offen sc1
    s_add_u32 s80, s80, 16384
    v_mov_b32 v62, v51
    buffer_store_dwordx2 v[62:63], v21, s[12:15], s80 offen sc1
    s_add_u32 s80, s80, 16384
    s_waitcnt vmcnt(28)
    v_mov_b32 v56, v52
    buffer_store_dwordx2 v[56:57], v21, s[12:15], s80 offen sc1
    s_add_u32 s80, s80, 16384
    v_mov_b32 v58, v53
    buffer_store_dwordx2 v[58:59], v21, s[12:15], s80 offen sc1
    s_add_u32 s80, s80, 16384
    v_mov_b32 v60, v54
    buffer_store_dwordx2 v[60:61], v21, s[12:15], s80 offen sc1
    s_add_u32 s80, s80, 16384
    v_mov_b32 v62, v55
    buffer_store_dwordx2 v[62:63], v21, s[12:15], s80 offen sc1
    s_branch L_A_join
L_roleK:
    s_lshr_b32 s80, s5, 1
    s_add_u32 s81, s76, s80
    s_and_b32 s82, s5, 1
    s_lshl_b32 s82, s82, 6
    s_lshl_b32 s83, s81, 7
    s_add_u32 s83, s83, s82
    v_add_u32 v21, s83, v1
    v_lshlrev_b32 v21, 1, v21
    s_lshl_b32 s81, s81, 1
    v_mov_b32 v22, s81
    buffer_load_ushort v24, v21, s[20:23], 0 offen
    buffer_load_ushort v25, v21, s[24:27], 0 offen
    buffer_load_ushort v26, v21, s[28:31], 0 offen
    buffer_load_ushort v27, v21, s[32:35], 0 offen
    buffer_load_ushort v28, v21, s[36:39], 0 offen
    buffer_load_ushort v29, v21, s[40:43], 0 offen
    buffer_load_ushort v30, v22, s[44:47], 0 offen
    s_mul_i32 s81, s80, 26112
    v_add_u32 v22, s82, v1
    v_lshlrev_b32 v22, 2, v22
    v_add_u32 v23, s81, v22
    s_mul_i32 s81, s80, 8704
    s_add_u32 s81, s81, 52224
    v_add_u32 v22, s81, v22
    s_load_dword s4, s[12:13], 0
    v_lshlrev_b32 v5, 4, v2
    v_lshl_add_u32 v5, v3, 9, v5
    v_and_b32 v16, 255, v0
    v_lshlrev_b32 v16, 3, v16
    s_lshr_b32 s80, s5, 2
    s_mul_i32 s80, s80, 5120
    s_add_u32 s80, s80, 69632
    v_cvt_f32_u32 v17, s80
    s_add_u32 s80, s80, 5118
    v_mov_b32 v18, s80
    v_cvt_f32_u32 v19, v16
    v_cmp_eq_u32 vcc, 0, v16
    v_add_f32 v20, 0xc0400000, v19
    v_cvt_pk_bf16_f32 v20, v20, v20
    v_and_b32 v20, 0xffff0000, v20
    v_fma_f32 v20, v20, 2.0, v17
    v_cvt_u32_f32 v113, v20
    v_cndmask_b32 v113, v113, v18, vcc
    v_add_f32 v20, -2.0, v19
    v_cvt_pk_bf16_f32 v20, v20, v20
    v_and_b32 v20, 0xffff0000, v20
    v_fma_f32 v20, v20, 2.0, v17
    v_cvt_u32_f32 v114, v20
    v_cndmask_b32 v114, v114, v18, vcc
    v_add_f32 v20, -1.0, v19
    v_cvt_pk_bf16_f32 v20, v20, v20
    v_and_b32 v20, 0xffff0000, v20
    v_fma_f32 v20, v20, 2.0, v17
    v_cvt_u32_f32 v115, v20
    v_cndmask_b32 v115, v115, v18, vcc
    v_add_f32 v20, 0x0, v19
    v_cvt_pk_bf16_f32 v20, v20, v20
    v_and_b32 v20, 0xffff0000, v20
    v_fma_f32 v20, v20, 2.0, v17
    v_cvt_u32_f32 v116, v20
    v_add_f32 v20, 1.0, v19
    v_cvt_pk_bf16_f32 v20, v20, v20
    v_and_b32 v20, 0xffff0000, v20
    v_fma_f32 v20, v20, 2.0, v17
    v_cvt_u32_f32 v117, v20
    v_add_f32 v20, 2.0, v19
    v_cvt_pk_bf16_f32 v20, v20, v20
    v_and_b32 v20, 0xffff0000, v20
    v_fma_f32 v20, v20, 2.0, v17
    v_cvt_u32_f32 v118, v20
    v_add_f32 v20, 0x40400000, v19
    v_cvt_pk_bf16_f32 v20, v20, v20
    v_and_b32 v20, 0xffff0000, v20
    v_fma_f32 v20, v20, 2.0, v17
    v_cvt_u32_f32 v119, v20
    v_add_f32 v20, 4.0, v19
    v_cvt_pk_bf16_f32 v20, v20, v20
    v_and_b32 v20, 0xffff0000, v20
    v_fma_f32 v20, v20, 2.0, v17
    v_cvt_u32_f32 v120, v20
    v_add_f32 v20, 0x40a00000, v19
    v_cvt_pk_bf16_f32 v20, v20, v20
    v_and_b32 v20, 0xffff0000, v20
    v_fma_f32 v20, v20, 2.0, v17
    v_cvt_u32_f32 v121, v20
    v_add_f32 v20, 0x40c00000, v19
    v_cvt_pk_bf16_f32 v20, v20, v20
    v_and_b32 v20, 0xffff0000, v20
    v_fma_f32 v20, v20, 2.0, v17
    v_cvt_u32_f32 v122, v20
    v_add_f32 v20, 0x40e00000, v19
    v_cvt_pk_bf16_f32 v20, v20, v20
    v_and_b32 v20, 0xffff0000, v20
    v_fma_f32 v20, v20, 2.0, v17
    v_cvt_u32_f32 v123, v20
    s_cmp_ge_u32 s5, 3
    s_cselect_b32 s80, 1, 0
    s_mul_i32 s81, s80, 3
    s_sub_u32 s81, s5, s81
    s_mul_i32 s82, s80, 26112
    s_mul_i32 s83, s81, 8704
    s_add_u32 s82, s82, s83
    v_mul_u32_u24 v16, 544, v2
    v_lshl_add_u32 v16, v3, 4, v16
    v_add_u32 v108, s82, v16
    s_mul_i32 s82, s80, 8704
    s_add_u32 s82, s82, 52224
    v_add_u32 v109, s82, v16
    s_mov_b32 s82, 262144
    s_cmp_eq_u32 s81, 1
    s_cselect_b32 s82, 25166080, s82
    s_cmp_eq_u32 s81, 2
    s_cselect_b32 s82, 100664320, s82
    s_mov_b32 s83, 8650880
    s_cmp_eq_u32 s81, 1
    s_cselect_b32 s83, 33817088, s83
    s_cmp_eq_u32 s81, 2
    s_cselect_b32 s83, 134285312, s83
    s_mov_b32 s87, 16843009
    s_cmp_eq_u32 s81, 1
    s_cselect_b32 s87, 2155872770, s87
    s_cmp_eq_u32 s81, 2
    s_cselect_b32 s87, 2155905152, s87
    v_cmp_gt_u32 vcc, 2, v3
    v_mov_b32 v16, s83
    v_mov_b32 v17, s82
    v_cndmask_b32 v16, v16, v17, vcc
    v_and_b32 v17, 1, v3
    v_lshlrev_b32 v17, 4, v17
    v_bfe_u32 v16, v16, v17, 16
    v_lshlrev_b32 v17, 3, v3
    v_bfe_u32 v17, s87, v17, 8
    v_lshl_add_u32 v16, v2, 3, v16
    s_mul_i32 s82, s80, 5120
    s_add_u32 s82, s82, 69632
    v_lshlrev_b32 v16, 1, v16
    v_add_u32 v104, s82, v16
    v_lshlrev_b32 v17, 1, v17
    v_add_u32 v105, v104, v17
    v_add_u32 v106, v105, v17
    v_add_u32 v107, v106, v17
    s_lshl_b32 s80, s5, 12
    v_add_u32 v9, s80, v4
    v_lshrrev_b32 v16, 3, v1
    v_cmp_gt_u32 vcc, 6, v16
    v_mov_b32 v17, 0
    s_nop 0
    v_cndmask_b32 v16, v17, v16, vcc
    v_lshrrev_b32 v17, 1, v16
    v_lshlrev_b32 v17, 9, v17
    v_and_b32 v16, 1, v16
    v_add_u32 v17, v17, v16
    v_add_u32 v17, s76, v17
    v_and_b32 v16, 7, v1
    v_mul_u32_u24 v16, 3072, v16
    v_add_u32 v17, v17, v16
    v_lshlrev_b32 v10, 3, v17
    s_lshr_b32 s82, s5, 2
    s_and_b32 s83, s5, 3
    s_mul_i32 s80, s82, 4672
    s_lshl_b32 s81, s83, 6
    s_sub_u32 s80, s80, s81
    s_add_u32 s80, s80, 151776
    v_lshlrev_b32 v6, 5, v2
    v_lshl_add_u32 v6, v3, 4, v6
    v_add_u32 v6, s80, v6
    s_mul_i32 s80, s82, 16640
    s_add_u32 s80, s80, s81
    s_add_u32 s80, s80, 79928
    v_lshrrev_b32 v7, 2, v2
    v_mul_u32_u24 v7, 4160, v7
    v_and_b32 v16, 3, v2
    v_lshl_add_u32 v7, v16, 3, v7
    v_lshlrev_b32 v16, 4, v3
    v_sub_u32 v7, v7, v16
    v_add_u32 v7, s80, v7
    s_lshl_b32 s80, s5, 13
    v_add_u32 v8, s80, v4
    v_lshlrev_b32 v16, 4, v2
    v_lshl_add_u32 v16, v3, 2, v16
    s_lshl_b32 s80, s5, 8
    v_add_u32 v16, s80, v16
    v_lshlrev_b32 v11, 2, v16
    v_add_u32 v11, 143360, v11
    v_lshlrev_b32 v12, 1, v16
    v_add_u32 v12, 152064, v12
    v_lshrrev_b32 v13, 1, v2
    v_lshlrev_b32 v13, 15, v13
    v_and_b32 v16, 1, v2
    v_lshl_add_u32 v13, v16, 5, v13
    v_and_b32 v16, 1, v3
    v_lshl_add_u32 v13, v16, 6, v13
    v_lshrrev_b32 v16, 1, v3
    v_lshl_add_u32 v13, v16, 4, v13
    s_waitcnt lgkmcnt(0)
    s_add_u32 s4, s4, 1
    s_lshl_b32 s80, s2, 2
    s_add_u32 s80, s80, s5
    s_add_u32 s80, s80, 128
    s_cmp_lt_u32 s80, 952
    s_cselect_b32 s91, 4, 0
    s_cselect_b32 s80, s80, 128
    s_mov_b64 s[92:93], s[60:61]
    s_mov_b32 s94, 524288
    s_mov_b32 s95, 0x20000
    s_mov_b32 s90, 13369344
    s_mov_b32 s96, 16384
    s_mov_b32 s88, 1024
    s_mov_b32 s81, s80
    s_cmp_ge_u32 s80, 128
    s_cselect_b64 s[92:93], s[64:65], s[92:93]
    s_cselect_b32 s90, 13893632, s90
    s_cselect_b32 s82, 128, 0
    s_sub_u32 s81, s80, s82
    s_cmp_ge_u32 s80, 256
    s_cselect_b64 s[92:93], s[68:69], s[92:93]
    s_cselect_b32 s94, 1409024, s94
    s_cselect_b32 s90, 14417920, s90
    s_cselect_b32 s88, 2752, s88
    s_cselect_b32 s82, 256, 0
    s_cselect_b32 s83, 1, 0
    s_cmp_lg_u32 s83, 0
    s_sub_u32 s82, s80, s82
    s_cmp_lg_u32 s83, 0
    s_cselect_b32 s81, s82, s81
    s_and_b32 s82, s81, 15
    s_lshr_b32 s83, s81, 4
    s_mov_b32 s87, 16
    s_cmp_ge_u32 s80, 608
    s_cselect_b64 s[92:93], s[72:73], s[92:93]
    s_cselect_b32 s90, 15826944, s90
    s_cselect_b32 s88, 1024, s88
    s_cselect_b32 s87, 43, s87
    s_cselect_b32 s96, 44032, s96
    s_sub_u32 s81, s80, 608
    s_lshr_b32 s97, s81, 3
    s_and_b32 s81, s81, 7
    s_cmp_ge_u32 s80, 608
    s_cselect_b32 s82, s97, s82
    s_cselect_b32 s83, s81, s83
    s_cselect_b32 s81, 0, s83
    s_cmp_eq_u32 s81, 21
    s_cselect_b32 s81, 2, 4
    s_min_u32 s91, s91, s81
    s_lshl_b32 s81, s83, 2
    s_mul_i32 s81, s81, s87
    s_add_u32 s81, s81, s82
    s_lshl_b32 s81, s81, 10
    s_add_u32 s90, s90, s81
    s_mul_i32 s82, s82, s88
    s_lshl_b32 s82, s82, 5
    s_lshl_b32 s83, s83, 7
    s_add_u32 s82, s82, s83
    v_lshrrev_b32 v100, 3, v1
    v_mul_lo_u32 v100, v100, s88
    v_and_b32 v101, 7, v1
    v_lshl_add_u32 v102, v101, 4, v100
    s_lshl_b32 s81, s5, 12
    s_add_u32 s97, s81, 113152
    s_lshl_b32 s74, s88, 3
    s_mov_b32 s75, s82
    s_waitcnt vmcnt(0)
    v_lshlrev_b32 v24, 16, v24
    v_lshlrev_b32 v25, 16, v25
    v_lshlrev_b32 v26, 16, v26
    v_lshlrev_b32 v27, 16, v27
    v_lshlrev_b32 v28, 16, v28
    v_lshlrev_b32 v29, 16, v29
    v_lshlrev_b32 v30, 16, v30
    v_mul_f32 v32, 0x3fb8aa3b, v30
    v_mov_b32 v31, 0x3fb8aa3b
    v_fma_f32 v33, v30, v31, -v32
    v_fmamk_f32 v33, v30, 0x32a57060, v33
    v_exp_f32 v32, v32
    v_mul_f32 v33, 0x3f317218, v33
    v_fma_f32 v32, v32, v33, v32
    v_cvt_pk_bf16_f32 v32, v32, v32
    v_lshlrev_b32 v30, 16, v32
    v_mul_f32 v24, v24, v30
    v_mul_f32 v25, v25, v30
    v_mul_f32 v24, 0x3fb8aa3b, v24
    v_mul_f32 v25, 0x3e22f983, v25
    v_mul_f32 v26, v26, v30
    v_mul_f32 v27, v27, v30
    v_exp_f32 v56, v24
    v_mul_f32 v60, 0x41000000, v24
    v_mul_f32 v64, 0x43000000, v24
    v_fract_f32 v57, v25
    v_mul_f32 v61, 0x41000000, v25
    v_mul_f32 v65, 0x43000000, v25
    v_cos_f32 v58, v57
    v_exp_f32 v60, v60
    v_exp_f32 v64, v64
    v_sin_f32 v59, v57
    v_fract_f32 v61, v61
    v_fract_f32 v65, v65
    v_mul_f32 v34, v56, v58
    v_cos_f32 v62, v61
    v_cos_f32 v66, v65
    v_mul_f32 v35, v56, v59
    v_sin_f32 v63, v61
    v_sin_f32 v67, v65
    v_mul_f32 v36, v60, v62
    v_mul_f32 v38, v64, v66
    v_mul_f32 v37, v60, v63
    v_mul_f32 v39, v64, v67
    v_pk_mul_f32 v[44:45], v[34:35], v[34:35] op_sel:[0,0] op_sel_hi:[0,1]
    v_pk_mul_f32 v[32:33], v[26:27], v[28:29] op_sel:[0,0] op_sel_hi:[0,1]
    v_pk_fma_f32 v[44:45], v[34:35], v[34:35], v[44:45] op_sel:[1,1,0] op_sel_hi:[1,0,1] neg_lo:[1,0,0]
    v_pk_fma_f32 v[32:33], v[26:27], v[28:29], v[32:33] op_sel:[1,1,0] op_sel_hi:[1,0,1] neg_lo:[1,0,0]
    v_pk_mul_f32 v[46:47], v[44:45], v[34:35] op_sel:[0,0] op_sel_hi:[0,1]
    v_pk_mul_f32 v[48:49], v[44:45], v[44:45] op_sel:[0,0] op_sel_hi:[0,1]
    v_pk_fma_f32 v[46:47], v[44:45], v[34:35], v[46:47] op_sel:[1,1,0] op_sel_hi:[1,0,1] neg_lo:[1,0,0]
    v_pk_fma_f32 v[48:49], v[44:45], v[44:45], v[48:49] op_sel:[1,1,0] op_sel_hi:[1,0,1] neg_lo:[1,0,0]
    v_pk_mul_f32 v[50:51], v[48:49], v[34:35] op_sel:[0,0] op_sel_hi:[0,1]
    v_pk_mul_f32 v[52:53], v[48:49], v[44:45] op_sel:[0,0] op_sel_hi:[0,1]
    v_pk_mul_f32 v[54:55], v[48:49], v[46:47] op_sel:[0,0] op_sel_hi:[0,1]
    v_pk_fma_f32 v[50:51], v[48:49], v[34:35], v[50:51] op_sel:[1,1,0] op_sel_hi:[1,0,1] neg_lo:[1,0,0]
    v_pk_fma_f32 v[52:53], v[48:49], v[44:45], v[52:53] op_sel:[1,1,0] op_sel_hi:[1,0,1] neg_lo:[1,0,0]
    v_pk_fma_f32 v[54:55], v[48:49], v[46:47], v[54:55] op_sel:[1,1,0] op_sel_hi:[1,0,1] neg_lo:[1,0,0]
    v_mov_b32 v26, 0x00003f80
    ds_write_b32 v22, v26 offset:0
    v_cvt_pk_bf16_f32 v27, v32, -v33
    v_pk_mul_f32 v[96:97], v[32:33], v[34:35] op_sel:[0,0] op_sel_hi:[0,1]
    v_pk_mul_f32 v[98:99], v[32:33], v[44:45] op_sel:[0,0] op_sel_hi:[0,1]
    ds_write_b32 v23, v27 offset:0
    v_pk_fma_f32 v[96:97], v[32:33], v[34:35], v[96:97] op_sel:[1,1,0] op_sel_hi:[1,0,1] neg_lo:[1,0,0]
    v_pk_fma_f32 v[98:99], v[32:33], v[44:45], v[98:99] op_sel:[1,1,0] op_sel_hi:[1,0,1] neg_lo:[1,0,0]
    v_cvt_pk_bf16_f32 v28, v96, -v97
    v_cvt_pk_bf16_f32 v29, v98, -v99
    v_cvt_pk_bf16_f32 v26, v36, v37
    ds_write_b32 v23, v28 offset:544
    ds_write_b32 v23, v29 offset:1088
    ds_write_b32 v22, v26 offset:544
    v_pk_mul_f32 v[94:95], v[32:33], v[46:47] op_sel:[0,0] op_sel_hi:[0,1]
    v_pk_mul_f32 v[96:97], v[32:33], v[48:49] op_sel:[0,0] op_sel_hi:[0,1]
    v_pk_mul_f32 v[98:99], v[32:33], v[50:51] op_sel:[0,0] op_sel_hi:[0,1]
    v_pk_fma_f32 v[94:95], v[32:33], v[46:47], v[94:95] op_sel:[1,1,0] op_sel_hi:[1,0,1] neg_lo:[1,0,0]
    v_pk_fma_f32 v[96:97], v[32:33], v[48:49], v[96:97] op_sel:[1,1,0] op_sel_hi:[1,0,1] neg_lo:[1,0,0]
    v_pk_fma_f32 v[98:99], v[32:33], v[50:51], v[98:99] op_sel:[1,1,0] op_sel_hi:[1,0,1] neg_lo:[1,0,0]
    v_cvt_pk_bf16_f32 v30, v94, -v95
    v_cvt_pk_bf16_f32 v31, v96, -v97
    v_cvt_pk_bf16_f32 v26, v98, -v99
    ds_write_b32 v23, v30 offset:1632
    ds_write_b32 v23, v31 offset:2176
    ds_write_b32 v23, v26 offset:2720
    v_pk_mul_f32 v[92:93], v[36:37], v[36:37] op_sel:[0,0] op_sel_hi:[0,1]
    v_pk_fma_f32 v[92:93], v[36:37], v[36:37], v[92:93] op_sel:[1,1,0] op_sel_hi:[1,0,1] neg_lo:[1,0,0]
    v_cvt_pk_bf16_f32 v27, v92, v93
    ds_write_b32 v22, v27 offset:1088
    v_pk_mul_f32 v[94:95], v[32:33], v[52:53] op_sel:[0,0] op_sel_hi:[0,1]
    v_pk_mul_f32 v[96:97], v[32:33], v[54:55] op_sel:[0,0] op_sel_hi:[0,1]
    v_pk_mul_f32 v[56:57], v[32:33], v[38:39] op_sel:[0,0] op_sel_hi:[0,1]
    v_pk_fma_f32 v[94:95], v[32:33], v[52:53], v[94:95] op_sel:[1,1,0] op_sel_hi:[1,0,1] neg_lo:[1,0,0]
    v_pk_fma_f32 v[96:97], v[32:33], v[54:55], v[96:97] op_sel:[1,1,0] op_sel_hi:[1,0,1] neg_lo:[1,0,0]
    v_pk_fma_f32 v[56:57], v[32:33], v[38:39], v[56:57] op_sel:[1,1,0] op_sel_hi:[1,0,1] neg_lo:[1,0,0]
    v_cvt_pk_bf16_f32 v27, v94, -v95
    v_cvt_pk_bf16_f32 v28, v96, -v97
    ds_write_b32 v23, v27 offset:3264
    ds_write_b32 v23, v28 offset:3808
    v_pk_mul_f32 v[88:89], v[92:93], v[36:37] op_sel:[0,0] op_sel_hi:[0,1]
    v_cvt_pk_bf16_f32 v29, v56, -v57
    v_pk_mul_f32 v[98:99], v[56:57], v[34:35] op_sel:[0,0] op_sel_hi:[0,1]
    v_pk_fma_f32 v[88:89], v[92:93], v[36:37], v[88:89] op_sel:[1,1,0] op_sel_hi:[1,0,1] neg_lo:[1,0,0]
    ds_write_b32 v23, v29 offset:4352
    v_pk_fma_f32 v[98:99], v[56:57], v[34:35], v[98:99] op_sel:[1,1,0] op_sel_hi:[1,0,1] neg_lo:[1,0,0]
    v_cvt_pk_bf16_f32 v28, v88, v89
    v_cvt_pk_bf16_f32 v30, v98, -v99
    v_pk_mul_f32 v[94:95], v[56:57], v[44:45] op_sel:[0,0] op_sel_hi:[0,1]
    ds_write_b32 v22, v28 offset:1632
    ds_write_b32 v23, v30 offset:4896
    v_pk_fma_f32 v[94:95], v[56:57], v[44:45], v[94:95] op_sel:[1,1,0] op_sel_hi:[1,0,1] neg_lo:[1,0,0]
    v_cvt_pk_bf16_f32 v31, v94, -v95
    v_pk_mul_f32 v[90:91], v[88:89], v[36:37] op_sel:[0,0] op_sel_hi:[0,1]
    v_pk_mul_f32 v[96:97], v[56:57], v[46:47] op_sel:[0,0] op_sel_hi:[0,1]
    ds_write_b32 v23, v31 offset:5440
    v_pk_fma_f32 v[90:91], v[88:89], v[36:37], v[90:91] op_sel:[1,1,0] op_sel_hi:[1,0,1] neg_lo:[1,0,0]
    v_pk_fma_f32 v[96:97], v[56:57], v[46:47], v[96:97] op_sel:[1,1,0] op_sel_hi:[1,0,1] neg_lo:[1,0,0]
    v_cvt_pk_bf16_f32 v29, v90, v91
    v_cvt_pk_bf16_f32 v26, v96, -v97
    v_pk_mul_f32 v[98:99], v[56:57], v[48:49] op_sel:[0,0] op_sel_hi:[0,1]
    ds_write_b32 v22, v29 offset:2176
    ds_write_b32 v23, v26 offset:5984
    v_pk_fma_f32 v[98:99], v[56:57], v[48:49], v[98:99] op_sel:[1,1,0] op_sel_hi:[1,0,1] neg_lo:[1,0,0]
    v_cvt_pk_bf16_f32 v27, v98, -v99
    v_pk_mul_f32 v[94:95], v[56:57], v[50:51] op_sel:[0,0] op_sel_hi:[0,1]
    v_pk_mul_f32 v[92:93], v[90:91], v[36:37] op_sel:[0,0] op_sel_hi:[0,1]
    ds_write_b32 v23, v27 offset:6528
    v_pk_fma_f32 v[94:95], v[56:57], v[50:51], v[94:95] op_sel:[1,1,0] op_sel_hi:[1,0,1] neg_lo:[1,0,0]
    v_pk_fma_f32 v[92:93], v[90:91], v[36:37], v[92:93] op_sel:[1,1,0] op_sel_hi:[1,0,1] neg_lo:[1,0,0]
    v_cvt_pk_bf16_f32 v28, v94, -v95
    v_cvt_pk_bf16_f32 v30, v92, v93
    v_pk_mul_f32 v[96:97], v[56:57], v[52:53] op_sel:[0,0] op_sel_hi:[0,1]
    ds_write_b32 v23, v28 offset:7072
    ds_write_b32 v22, v30 offset:2720
    v_pk_fma_f32 v[96:97], v[56:57], v[52:53], v[96:97] op_sel:[1,1,0] op_sel_hi:[1,0,1] neg_lo:[1,0,0]
    v_cvt_pk_bf16_f32 v29, v96, -v97
    v_pk_mul_f32 v[98:99], v[56:57], v[54:55] op_sel:[0,0] op_sel_hi:[0,1]
    v_pk_mul_f32 v[58:59], v[56:57], v[38:39] op_sel:[0,0] op_sel_hi:[0,1]
    ds_write_b32 v23, v29 offset:7616
    v_pk_fma_f32 v[98:99], v[56:57], v[54:55], v[98:99] op_sel:[1,1,0] op_sel_hi:[1,0,1] neg_lo:[1,0,0]
    v_pk_fma_f32 v[58:59], v[56:57], v[38:39], v[58:59] op_sel:[1,1,0] op_sel_hi:[1,0,1] neg_lo:[1,0,0]
    v_cvt_pk_bf16_f32 v30, v98, -v99
    v_pk_mul_f32 v[88:89], v[92:93], v[36:37] op_sel:[0,0] op_sel_hi:[0,1]
    ds_write_b32 v23, v30 offset:8160
    v_pk_fma_f32 v[88:89], v[92:93], v[36:37], v[88:89] op_sel:[1,1,0] op_sel_hi:[1,0,1] neg_lo:[1,0,0]
    v_cvt_pk_bf16_f32 v31, v88, v89
    ds_write_b32 v22, v31 offset:3264
    v_cvt_pk_bf16_f32 v31, v58, -v59
    v_pk_mul_f32 v[94:95], v[58:59], v[44:45] op_sel:[0,0] op_sel_hi:[0,1]
    v_pk_mul_f32 v[96:97], v[58:59], v[48:49] op_sel:[0,0] op_sel_hi:[0,1]
    ds_write_b32 v23, v31 offset:8704
    v_pk_fma_f32 v[94:95], v[58:59], v[44:45], v[94:95] op_sel:[1,1,0] op_sel_hi:[1,0,1] neg_lo:[1,0,0]
    v_pk_fma_f32 v[96:97], v[58:59], v[48:49], v[96:97] op_sel:[1,1,0] op_sel_hi:[1,0,1] neg_lo:[1,0,0]
    v_cvt_pk_bf16_f32 v26, v94, -v95
    v_cvt_pk_bf16_f32 v27, v96, -v97
    ds_write_b32 v23, v26 offset:9248
    ds_write_b32 v23, v27 offset:9792
    v_pk_mul_f32 v[90:91], v[88:89], v[36:37] op_sel:[0,0] op_sel_hi:[0,1]
    v_pk_mul_f32 v[98:99], v[58:59], v[52:53] op_sel:[0,0] op_sel_hi:[0,1]
    v_pk_mul_f32 v[60:61], v[58:59], v[38:39] op_sel:[0,0] op_sel_hi:[0,1]
    v_pk_fma_f32 v[90:91], v[88:89], v[36:37], v[90:91] op_sel:[1,1,0] op_sel_hi:[1,0,1] neg_lo:[1,0,0]
    v_pk_fma_f32 v[98:99], v[58:59], v[52:53], v[98:99] op_sel:[1,1,0] op_sel_hi:[1,0,1] neg_lo:[1,0,0]
    v_pk_fma_f32 v[60:61], v[58:59], v[38:39], v[60:61] op_sel:[1,1,0] op_sel_hi:[1,0,1] neg_lo:[1,0,0]
    v_cvt_pk_bf16_f32 v26, v90, v91
    v_cvt_pk_bf16_f32 v28, v98, -v99
    v_cvt_pk_bf16_f32 v29, v60, -v61
    ds_write_b32 v22, v26 offset:3808
    ds_write_b32 v23, v28 offset:10336
    ds_write_b32 v23, v29 offset:10880
    v_pk_mul_f32 v[92:93], v[90:91], v[36:37] op_sel:[0,0] op_sel_hi:[0,1]
    v_pk_mul_f32 v[94:95], v[60:61], v[44:45] op_sel:[0,0] op_sel_hi:[0,1]
    v_pk_mul_f32 v[96:97], v[60:61], v[48:49] op_sel:[0,0] op_sel_hi:[0,1]
    v_pk_fma_f32 v[92:93], v[90:91], v[36:37], v[92:93] op_sel:[1,1,0] op_sel_hi:[1,0,1] neg_lo:[1,0,0]
    v_pk_fma_f32 v[94:95], v[60:61], v[44:45], v[94:95] op_sel:[1,1,0] op_sel_hi:[1,0,1] neg_lo:[1,0,0]
    v_pk_fma_f32 v[96:97], v[60:61], v[48:49], v[96:97] op_sel:[1,1,0] op_sel_hi:[1,0,1] neg_lo:[1,0,0]
    v_cvt_pk_bf16_f32 v27, v92, v93
    v_cvt_pk_bf16_f32 v30, v94, -v95
    v_cvt_pk_bf16_f32 v31, v96, -v97
    ds_write_b32 v22, v27 offset:4352
    ds_write_b32 v23, v30 offset:11424
    ds_write_b32 v23, v31 offset:11968
    v_pk_mul_f32 v[98:99], v[60:61], v[52:53] op_sel:[0,0] op_sel_hi:[0,1]
    v_pk_mul_f32 v[88:89], v[92:93], v[36:37] op_sel:[0,0] op_sel_hi:[0,1]
    v_pk_mul_f32 v[62:63], v[60:61], v[38:39] op_sel:[0,0] op_sel_hi:[0,1]
    v_pk_fma_f32 v[98:99], v[60:61], v[52:53], v[98:99] op_sel:[1,1,0] op_sel_hi:[1,0,1] neg_lo:[1,0,0]
    v_pk_fma_f32 v[88:89], v[92:93], v[36:37], v[88:89] op_sel:[1,1,0] op_sel_hi:[1,0,1] neg_lo:[1,0,0]
    v_pk_fma_f32 v[62:63], v[60:61], v[38:39], v[62:63] op_sel:[1,1,0] op_sel_hi:[1,0,1] neg_lo:[1,0,0]
    v_cvt_pk_bf16_f32 v26, v98, -v99
    v_cvt_pk_bf16_f32 v28, v88, v89
    v_cvt_pk_bf16_f32 v27, v62, -v63
    ds_write_b32 v23, v26 offset:12512
    ds_write_b32 v22, v28 offset:4896
    ds_write_b32 v23, v27 offset:13056
    v_pk_mul_f32 v[94:95], v[62:63], v[48:49] op_sel:[0,0] op_sel_hi:[0,1]
    v_pk_mul_f32 v[90:91], v[88:89], v[36:37] op_sel:[0,0] op_sel_hi:[0,1]
    v_pk_mul_f32 v[64:65], v[62:63], v[38:39] op_sel:[0,0] op_sel_hi:[0,1]
    v_pk_fma_f32 v[94:95], v[62:63], v[48:49], v[94:95] op_sel:[1,1,0] op_sel_hi:[1,0,1] neg_lo:[1,0,0]
    v_pk_fma_f32 v[90:91], v[88:89], v[36:37], v[90:91] op_sel:[1,1,0] op_sel_hi:[1,0,1] neg_lo:[1,0,0]
    v_pk_fma_f32 v[64:65], v[62:63], v[38:39], v[64:65] op_sel:[1,1,0] op_sel_hi:[1,0,1] neg_lo:[1,0,0]
    v_cvt_pk_bf16_f32 v28, v94, -v95
    v_cvt_pk_bf16_f32 v29, v90, v91
    ds_write_b32 v23, v28 offset:15232
    ds_write_b32 v22, v29 offset:5440
    v_cvt_pk_bf16_f32 v29, v64, -v65
    v_pk_mul_f32 v[96:97], v[64:65], v[48:49] op_sel:[0,0] op_sel_hi:[0,1]
    ds_write_b32 v23, v29 offset:13600
    v_pk_fma_f32 v[96:97], v[64:65], v[48:49], v[96:97] op_sel:[1,1,0] op_sel_hi:[1,0,1] neg_lo:[1,0,0]
    v_cvt_pk_bf16_f32 v30, v96, -v97
    ds_write_b32 v23, v30 offset:15776
    v_pk_mul_f32 v[92:93], v[90:91], v[36:37] op_sel:[0,0] op_sel_hi:[0,1]
    v_pk_mul_f32 v[66:67], v[64:65], v[38:39] op_sel:[0,0] op_sel_hi:[0,1]
    v_pk_fma_f32 v[92:93], v[90:91], v[36:37], v[92:93] op_sel:[1,1,0] op_sel_hi:[1,0,1] neg_lo:[1,0,0]
    v_pk_fma_f32 v[66:67], v[64:65], v[38:39], v[66:67] op_sel:[1,1,0] op_sel_hi:[1,0,1] neg_lo:[1,0,0]
    v_cvt_pk_bf16_f32 v30, v92, v93
    v_cvt_pk_bf16_f32 v31, v66, -v67
    v_pk_mul_f32 v[98:99], v[66:67], v[48:49] op_sel:[0,0] op_sel_hi:[0,1]
    ds_write_b32 v22, v30 offset:5984
    ds_write_b32 v23, v31 offset:14144
    v_pk_fma_f32 v[98:99], v[66:67], v[48:49], v[98:99] op_sel:[1,1,0] op_sel_hi:[1,0,1] neg_lo:[1,0,0]
    v_cvt_pk_bf16_f32 v26, v98, -v99
    v_pk_mul_f32 v[88:89], v[92:93], v[36:37] op_sel:[0,0] op_sel_hi:[0,1]
    v_pk_mul_f32 v[68:69], v[66:67], v[38:39] op_sel:[0,0] op_sel_hi:[0,1]
    ds_write_b32 v23, v26 offset:16320
    v_pk_fma_f32 v[88:89], v[92:93], v[36:37], v[88:89] op_sel:[1,1,0] op_sel_hi:[1,0,1] neg_lo:[1,0,0]
    v_pk_fma_f32 v[68:69], v[66:67], v[38:39], v[68:69] op_sel:[1,1,0] op_sel_hi:[1,0,1] neg_lo:[1,0,0]
    v_cvt_pk_bf16_f32 v31, v88, v89
    v_cvt_pk_bf16_f32 v27, v68, -v69
    v_pk_mul_f32 v[94:95], v[68:69], v[48:49] op_sel:[0,0] op_sel_hi:[0,1]
    ds_write_b32 v22, v31 offset:6528
    ds_write_b32 v23, v27 offset:14688
    v_pk_fma_f32 v[94:95], v[68:69], v[48:49], v[94:95] op_sel:[1,1,0] op_sel_hi:[1,0,1] neg_lo:[1,0,0]
    v_cvt_pk_bf16_f32 v28, v94, -v95
    v_pk_mul_f32 v[90:91], v[88:89], v[36:37] op_sel:[0,0] op_sel_hi:[0,1]
    v_pk_mul_f32 v[70:71], v[68:69], v[38:39] op_sel:[0,0] op_sel_hi:[0,1]
    ds_write_b32 v23, v28 offset:16864
    v_pk_fma_f32 v[90:91], v[88:89], v[36:37], v[90:91] op_sel:[1,1,0] op_sel_hi:[1,0,1] neg_lo:[1,0,0]
    v_pk_fma_f32 v[70:71], v[68:69], v[38:39], v[70:71] op_sel:[1,1,0] op_sel_hi:[1,0,1] neg_lo:[1,0,0]
    v_cvt_pk_bf16_f32 v26, v90, v91
    v_cvt_pk_bf16_f32 v29, v70, -v71
    v_pk_mul_f32 v[72:73], v[70:71], v[38:39] op_sel:[0,0] op_sel_hi:[0,1]
    ds_write_b32 v22, v26 offset:7072
    ds_write_b32 v23, v29 offset:17408
    v_pk_fma_f32 v[72:73], v[70:71], v[38:39], v[72:73] op_sel:[1,1,0] op_sel_hi:[1,0,1] neg_lo:[1,0,0]
    v_pk_mul_f32 v[92:93], v[90:91], v[36:37] op_sel:[0,0] op_sel_hi:[0,1]
    v_cvt_pk_bf16_f32 v30, v72, -v73
    v_pk_mul_f32 v[74:75], v[72:73], v[38:39] op_sel:[0,0] op_sel_hi:[0,1]
    v_pk_fma_f32 v[92:93], v[90:91], v[36:37], v[92:93] op_sel:[1,1,0] op_sel_hi:[1,0,1] neg_lo:[1,0,0]
    ds_write_b32 v23, v30 offset:17952
    v_pk_fma_f32 v[74:75], v[72:73], v[38:39], v[74:75] op_sel:[1,1,0] op_sel_hi:[1,0,1] neg_lo:[1,0,0]
    v_cvt_pk_bf16_f32 v27, v92, v93
    v_cvt_pk_bf16_f32 v31, v74, -v75
    v_pk_mul_f32 v[88:89], v[92:93], v[36:37] op_sel:[0,0] op_sel_hi:[0,1]
    ds_write_b32 v22, v27 offset:7616
    ds_write_b32 v23, v31 offset:18496
    v_pk_fma_f32 v[88:89], v[92:93], v[36:37], v[88:89] op_sel:[1,1,0] op_sel_hi:[1,0,1] neg_lo:[1,0,0]
    v_cvt_pk_bf16_f32 v28, v88, v89
    v_pk_mul_f32 v[76:77], v[74:75], v[38:39] op_sel:[0,0] op_sel_hi:[0,1]
    ds_write_b32 v22, v28 offset:8160
    v_pk_fma_f32 v[76:77], v[74:75], v[38:39], v[76:77] op_sel:[1,1,0] op_sel_hi:[1,0,1] neg_lo:[1,0,0]
    v_cvt_pk_bf16_f32 v26, v76, -v77
    v_pk_mul_f32 v[78:79], v[76:77], v[38:39] op_sel:[0,0] op_sel_hi:[0,1]
    ds_write_b32 v23, v26 offset:19040
    v_pk_fma_f32 v[78:79], v[76:77], v[38:39], v[78:79] op_sel:[1,1,0] op_sel_hi:[1,0,1] neg_lo:[1,0,0]
    v_cvt_pk_bf16_f32 v27, v78, -v79
    v_pk_mul_f32 v[80:81], v[78:79], v[38:39] op_sel:[0,0] op_sel_hi:[0,1]
    ds_write_b32 v23, v27 offset:19584
    v_pk_fma_f32 v[80:81], v[78:79], v[38:39], v[80:81] op_sel:[1,1,0] op_sel_hi:[1,0,1] neg_lo:[1,0,0]
    v_cvt_pk_bf16_f32 v28, v80, -v81
    v_pk_mul_f32 v[82:83], v[80:81], v[38:39] op_sel:[0,0] op_sel_hi:[0,1]
    ds_write_b32 v23, v28 offset:20128
    v_pk_fma_f32 v[82:83], v[80:81], v[38:39], v[82:83] op_sel:[1,1,0] op_sel_hi:[1,0,1] neg_lo:[1,0,0]
    v_cvt_pk_bf16_f32 v29, v82, -v83
    v_pk_mul_f32 v[84:85], v[82:83], v[38:39] op_sel:[0,0] op_sel_hi:[0,1]
    ds_write_b32 v23, v29 offset:20672
    v_pk_fma_f32 v[84:85], v[82:83], v[38:39], v[84:85] op_sel:[1,1,0] op_sel_hi:[1,0,1] neg_lo:[1,0,0]
    v_cvt_pk_bf16_f32 v30, v84, -v85
    v_pk_mul_f32 v[86:87], v[84:85], v[38:39] op_sel:[0,0] op_sel_hi:[0,1]
    ds_write_b32 v23, v30 offset:21216
    v_pk_fma_f32 v[86:87], v[84:85], v[38:39], v[86:87] op_sel:[1,1,0] op_sel_hi:[1,0,1] neg_lo:[1,0,0]
    v_cvt_pk_bf16_f32 v31, v86, -v87
    ds_write_b32 v23, v31 offset:21760
L_A_join:
    s_setprio 0
    v_mov_b32 v24, 0
    v_mov_b32 v25, 0
    v_mov_b32 v26, 0
    v_mov_b32 v27, 0
    v_lshrrev_b32 v21, 5, v0
    v_mul_u32_u24 v21, 4672, v21
    v_and_b32 v22, 31, v0
    v_lshl_add_u32 v21, v22, 4, v21
    v_add_u32 v21, 151552, v21
    v_subrev_u32 v22, 64, v0
    v_lshrrev_b32 v23, 1, v22
    v_mul_u32_u24 v23, 4160, v23
    v_and_b32 v22, 1, v0
    v_lshl_add_u32 v23, v22, 4, v23
    v_add_u32 v23, 79872, v23
    v_cmp_gt_u32 vcc, 64, v0
    s_nop 1
    v_cndmask_b32 v21, v23, v21, vcc
    v_mul_u32_u24 v22, 5120, v22
    v_add_u32 v22, 74750, v22
    s_cmp_ge_u32 s5, 2
    s_cbranch_scc1 L_z_3
    v_cmp_gt_u32 vcc, 80, v0
    s_and_saveexec_b64 s[98:99], vcc
    ds_write_b128 v21, v[24:27]
    ds_write_b16 v22, v24
    s_mov_b64 exec, s[98:99]
L_z_3:
    s_waitcnt lgkmcnt(0)
    s_barrier
    s_cmp_ge_u32 s5, 6
    s_cbranch_scc1 L_kmf_4
    ds_read_b128 v[24:27], v108 offset:0
    ds_read_b128 v[28:31], v109 offset:0
    ds_read_b128 v[32:35], v108 offset:64
    ds_read_b128 v[36:39], v109 offset:64
    ds_read_b128 v[40:43], v108 offset:128
    ds_read_b128 v[44:47], v109 offset:128
    ds_read_b128 v[48:51], v108 offset:192
    ds_read_b128 v[52:55], v109 offset:192
    ds_read_b128 v[56:59], v108 offset:256
    ds_read_b128 v[60:63], v109 offset:256
    ds_read_b128 v[64:67], v108 offset:320
    ds_read_b128 v[68:71], v109 offset:320
    ds_read_b128 v[72:75], v108 offset:384
    ds_read_b128 v[76:79], v109 offset:384
    ds_read_b128 v[80:83], v108 offset:448
    ds_read_b128 v[84:87], v109 offset:448
    s_waitcnt lgkmcnt(14)
    v_mfma_f32_16x16x32_bf16 v[88:91], v[24:27], v[28:31], 0
    s_waitcnt lgkmcnt(12)
    v_mfma_f32_16x16x32_bf16 v[92:95], v[32:35], v[36:39], 0
    s_waitcnt lgkmcnt(10)
    v_mfma_f32_16x16x32_bf16 v[88:91], v[40:43], v[44:47], v[88:91]
    s_waitcnt lgkmcnt(8)
    v_mfma_f32_16x16x32_bf16 v[92:95], v[48:51], v[52:55], v[92:95]
    s_waitcnt lgkmcnt(6)
    v_mfma_f32_16x16x32_bf16 v[88:91], v[56:59], v[60:63], v[88:91]
    s_waitcnt lgkmcnt(4)
    v_mfma_f32_16x16x32_bf16 v[92:95], v[64:67], v[68:71], v[92:95]
    s_waitcnt lgkmcnt(2)
    v_mfma_f32_16x16x32_bf16 v[88:91], v[72:75], v[76:79], v[88:91]
    s_waitcnt lgkmcnt(0)
    v_mfma_f32_16x16x32_bf16 v[92:95], v[80:83], v[84:87], v[92:95]
    s_nop 7
    v_add_f32 v88, v88, v92
    v_add_f32 v89, v89, v93
    v_add_f32 v90, v90, v94
    v_add_f32 v91, v91, v95
    v_cvt_pk_bf16_f32 v96, v88, v89
    v_cvt_pk_bf16_f32 v97, v90, v91
    ds_write_b16 v104, v96
    ds_write_b16_d16_hi v105, v96
    ds_write_b16 v106, v97
    ds_write_b16_d16_hi v107, v97
    s_waitcnt lgkmcnt(0)
L_kmf_4:
    s_barrier
    v_lshrrev_b32 v20, 1, v9
    s_lshl_b32 s87, s6, 5
    s_add_u32 s87, s87, s7
    s_lshl_b32 s87, s87, 14
    s_add_u32 s87, s87, 17235968
    s_mov_b32 s88, 8192
    buffer_load_dwordx4 v[128:131], v9, s[12:15], s88 offen sc1
    buffer_load_dwordx2 v[144:145], v20, s[12:15], s87 offen sc1
    buffer_load_dwordx4 v[132:135], v9, s[12:15], s88 offen offset:1024 sc1
    buffer_load_dwordx2 v[146:147], v20, s[12:15], s87 offen offset:512 sc1
    buffer_load_dwordx4 v[136:139], v9, s[12:15], s88 offen offset:2048 sc1
    buffer_load_dwordx2 v[148:149], v20, s[12:15], s87 offen offset:1024 sc1
    buffer_load_dwordx4 v[140:143], v9, s[12:15], s88 offen offset:3072 sc1
    buffer_load_dwordx2 v[150:151], v20, s[12:15], s87 offen offset:1536 sc1
    s_mov_b32 s82, 40960
    buffer_load_dwordx2 v[152:153], v10, s[12:15], s82 offen sc1
    s_cmp_lg_u32 s5, 7
    s_cbranch_scc1 L_modf_5
    v_lshrrev_b32 v14, 3, v1
    s_mul_i32 s80, s2, 12
    v_add_u32 v14, s80, v14
    v_and_b32 v15, 7, v1
    v_mul_u32_u24 v15, 3072, v15
    v_add_u32 v15, v15, v14
    v_lshlrev_b32 v154, 3, v15
    v_lshrrev_b32 v14, 3, v1
    v_and_b32 v15, 3, v14
    v_sub_u32 v14, v15, v14
    v_add_u32 v14, 8, v14
    v_lshl_add_u32 v155, v14, 3, v154
    s_mov_b32 s82, 40960
    buffer_load_dwordx2 v[156:157], v154, s[12:15], s82 offen sc1
    buffer_load_dwordx2 v[158:159], v155, s[12:15], s82 offen sc1
L_modf_5:
    ds_read_u16 v25, v113
    ds_read_u16 v26, v114
    ds_read_u16 v27, v115
    ds_read_u16 v28, v116
    ds_read_u16 v29, v117
    ds_read_u16 v30, v118
    ds_read_u16 v31, v119
    ds_read_u16 v32, v120
    ds_read_u16 v33, v121
    ds_read_u16 v34, v122
    ds_read_u16 v35, v123
    s_lshr_b32 s80, s5, 2
    s_mul_i32 s80, s80, 16640
    s_add_u32 s80, s80, 79904
    v_and_b32 v22, 255, v0
    v_lshl_add_u32 v21, v22, 4, s80
    s_waitcnt lgkmcnt(0)
    v_lshl_or_b32 v36, v29, 16, v28
    v_lshl_or_b32 v37, v31, 16, v30
    v_lshl_or_b32 v38, v33, 16, v32
    v_lshl_or_b32 v39, v35, 16, v34
    ds_write_b128 v21, v[36:39] offset:0
    v_lshl_or_b32 v40, v28, 16, v27
    v_lshl_or_b32 v41, v30, 16, v29
    v_lshl_or_b32 v42, v32, 16, v31
    v_lshl_or_b32 v43, v34, 16, v33
    ds_write_b128 v21, v[40:43] offset:4160
    v_lshl_or_b32 v44, v27, 16, v26
    v_lshl_or_b32 v45, v29, 16, v28
    v_lshl_or_b32 v46, v31, 16, v30
    v_lshl_or_b32 v47, v33, 16, v32
    ds_write_b128 v21, v[44:47] offset:8320
    v_lshl_or_b32 v48, v26, 16, v25
    v_lshl_or_b32 v49, v28, 16, v27
    v_lshl_or_b32 v50, v30, 16, v29
    v_lshl_or_b32 v51, v32, 16, v31
    ds_write_b128 v21, v[48:51] offset:12480
    s_mov_b32 s84, 0
    s_waitcnt vmcnt(0)
    v_min3_u32 v84, v129, v131, v133
    v_max3_u32 v85, v129, v131, v133
    v_min3_u32 v84, v84, v135, v137
    v_max3_u32 v85, v85, v135, v137
    v_min3_u32 v84, v84, v139, v141
    v_max3_u32 v85, v85, v139, v141
    v_min3_u32 v84, v84, v143, v153
    v_max3_u32 v85, v85, v143, v153
    v_min3_u32 v84, v84, v145, v147
    v_max3_u32 v85, v85, v145, v147
    v_min3_u32 v84, v84, v149, v151
    v_max3_u32 v85, v85, v149, v151
    v_cmp_ne_u32 vcc, s4, v84
    v_cmp_ne_u32 s[98:99], s4, v85
    s_nop 0
    s_or_b64 vcc, vcc, s[98:99]
    s_cbranch_vccz L_S1_ok
L_S1_poll:
    buffer_load_dwordx4 v[128:131], v9, s[12:15], s88 offen sc1
    buffer_load_dwordx2 v[144:145], v20, s[12:15], s87 offen sc1
    buffer_load_dwordx4 v[132:135], v9, s[12:15], s88 offen offset:1024 sc1
    buffer_load_dwordx2 v[146:147], v20, s[12:15], s87 offen offset:512 sc1
    buffer_load_dwordx4 v[136:139], v9, s[12:15], s88 offen offset:2048 sc1
    buffer_load_dwordx2 v[148:149], v20, s[12:15], s87 offen offset:1024 sc1
    buffer_load_dwordx4 v[140:143], v9, s[12:15], s88 offen offset:3072 sc1
    buffer_load_dwordx2 v[150:151], v20, s[12:15], s87 offen offset:1536 sc1
    s_mov_b32 s82, 40960
    buffer_load_dwordx2 v[152:153], v10, s[12:15], s82 offen sc1
    s_waitcnt vmcnt(0)
    v_min3_u32 v84, v129, v131, v133
    v_max3_u32 v85, v129, v131, v133
    v_min3_u32 v84, v84, v135, v137
    v_max3_u32 v85, v85, v135, v137
    v_min3_u32 v84, v84, v139, v141
    v_max3_u32 v85, v85, v139, v141
    v_min3_u32 v84, v84, v143, v153
    v_max3_u32 v85, v85, v143, v153
    v_min3_u32 v84, v84, v145, v147
    v_max3_u32 v85, v85, v145, v147
    v_min3_u32 v84, v84, v149, v151
    v_max3_u32 v85, v85, v149, v151
    v_cmp_ne_u32 vcc, s4, v84
    v_cmp_ne_u32 s[98:99], s4, v85
    s_nop 0
    s_or_b64 vcc, vcc, s[98:99]
    s_cbranch_vccz L_S1_ok
    s_add_u32 s84, s84, 1
    s_cmp_lt_u32 s84, 20000
    s_cbranch_scc1 L_S1_poll
L_S1_ok:
    s_cmp_ge_u32 s5, 4
    s_cbranch_scc1 L_swzdma_6
    v_mov_b32 v14, v102
    s_mov_b32 s82, s75
    s_add_u32 s81, s97, 0
    s_mov_b32 m0, s81
    s_nop 0
    buffer_load_dwordx4 v14, s[92:95], s82 offen lds
    s_add_u32 s82, s82, s74
    s_add_u32 s81, s97, 1024
    s_mov_b32 m0, s81
    s_nop 0
    buffer_load_dwordx4 v14, s[92:95], s82 offen lds
    s_add_u32 s82, s82, s74
    s_add_u32 s81, s97, 2048
    s_mov_b32 m0, s81
    s_nop 0
    buffer_load_dwordx4 v14, s[92:95], s82 offen lds
    s_add_u32 s82, s82, s74
    s_add_u32 s81, s97, 3072
    s_mov_b32 m0, s81
    s_nop 0
    buffer_load_dwordx4 v14, s[92:95], s82 offen lds
L_swzdma_6:
    v_lshrrev_b32 v23, 2, v9
    v_add_u32 v23, 143360, v23
    ds_write_b32 v23, v144 offset:0
    ds_write_b32 v23, v146 offset:256
    ds_write_b32 v23, v148 offset:512
    ds_write_b32 v23, v150 offset:768
    v_add_f32_dpp v152, v152, v152 quad_perm:[1,0,3,2] row_mask:0xf bank_mask:0xf
    s_nop 1
    v_add_f32_dpp v152, v152, v152 quad_perm:[2,3,0,1] row_mask:0xf bank_mask:0xf
    s_nop 1
    v_add_f32_dpp v152, v152, v152 row_half_mirror row_mask:0xf bank_mask:0xf
    s_nop 0
    v_readlane_b32 s64, v152, 0
    v_readlane_b32 s65, v152, 8
    v_readlane_b32 s66, v152, 16
    v_readlane_b32 s67, v152, 24
    v_readlane_b32 s68, v152, 32
    v_readlane_b32 s69, v152, 40
    v_mov_b32 v60, s64
    v_mov_b32 v62, s65
    v_mov_b32 v64, s66
    v_mov_b32 v66, s67
    v_mov_b32 v68, s68
    v_mov_b32 v70, s69
    v_add_f32 v64, 1.0, v64
    v_add_f32 v66, 1.0, v66
    s_lshr_b32 s86, s5, 2
    s_and_b32 s85, s5, 3
    s_lshl_b32 s80, s76, 1
    v_mov_b32 v77, s80
    buffer_load_dword v76, v77, s[48:51], 0 offen
    v_lshlrev_b32 v80, 16, v144
    v_lshlrev_b32 v82, 16, v146
    v_lshlrev_b32 v84, 16, v148
    v_lshlrev_b32 v86, 16, v150
    v_and_b32 v81, 0xffff0000, v144
    v_and_b32 v83, 0xffff0000, v146
    v_and_b32 v85, 0xffff0000, v148
    v_and_b32 v87, 0xffff0000, v150
    v_fma_f32 v80, v80, v128, -v130
    v_fma_f32 v82, v82, v132, -v134
    v_fma_f32 v84, v84, v136, -v138
    v_fma_f32 v86, v86, v140, -v142
    v_fma_f32 v81, v81, v128, -v130
    v_fma_f32 v83, v83, v132, -v134
    v_fma_f32 v85, v85, v136, -v138
    v_fma_f32 v87, v87, v140, -v142
    v_fma_f32 v80, v80, v64, v60
    v_fma_f32 v82, v82, v64, v60
    v_fma_f32 v84, v84, v64, v60
    v_fma_f32 v86, v86, v64, v60
    v_fma_f32 v81, v81, v66, v62
    v_fma_f32 v83, v83, v66, v62
    v_fma_f32 v85, v85, v66, v62
    v_fma_f32 v87, v87, v66, v62
    v_cvt_pk_bf16_f32 v96, v80, v81
    v_cvt_pk_bf16_f32 v97, v82, v83
    v_cvt_pk_bf16_f32 v98, v84, v85
    v_cvt_pk_bf16_f32 v99, v86, v87
    v_lshrrev_b32 v23, 3, v9
    v_add_u32 v23, 152064, v23
    ds_write_b16 v23, v96 offset:0
    ds_write_b16_d16_hi v23, v96 offset:4672
    ds_write_b16 v23, v97 offset:128
    ds_write_b16_d16_hi v23, v97 offset:4800
    ds_write_b16 v23, v98 offset:256
    ds_write_b16_d16_hi v23, v98 offset:4928
    ds_write_b16 v23, v99 offset:384
    ds_write_b16_d16_hi v23, v99 offset:5056
    s_waitcnt lgkmcnt(0)
    s_barrier
    s_cmp_lg_u32 s5, 7
    s_cbranch_scc1 L_modf_7
    s_waitcnt vmcnt(0)
    v_min3_u32 v86, v157, v159, v159
    v_max3_u32 v87, v157, v159, v159
    v_cmp_ne_u32 vcc, s4, v86
    v_cmp_ne_u32 s[98:99], s4, v87
    s_nop 0
    s_or_b64 vcc, vcc, s[98:99]
    s_cbranch_vccz L_modok_9
    s_mov_b32 s84, 0
L_modp_8:
    s_mov_b32 s82, 40960
    buffer_load_dwordx2 v[156:157], v154, s[12:15], s82 offen sc1
    buffer_load_dwordx2 v[158:159], v155, s[12:15], s82 offen sc1
    s_waitcnt vmcnt(0)
    v_min3_u32 v86, v157, v159, v159
    v_max3_u32 v87, v157, v159, v159
    v_cmp_ne_u32 vcc, s4, v86
    v_cmp_ne_u32 s[98:99], s4, v87
    s_nop 0
    s_or_b64 vcc, vcc, s[98:99]
    s_cbranch_vccz L_modok_9
    s_add_u32 s84, s84, 1
    s_cmp_lt_u32 s84, 20000
    s_cbranch_scc1 L_modp_8
L_modok_9:
    v_add_f32_dpp v156, v156, v156 quad_perm:[1,0,3,2] row_mask:0xf bank_mask:0xf
    s_nop 1
    v_add_f32_dpp v156, v156, v156 quad_perm:[2,3,0,1] row_mask:0xf bank_mask:0xf
    s_nop 1
    v_add_f32_dpp v156, v156, v156 row_half_mirror row_mask:0xf bank_mask:0xf
    v_add_f32_dpp v158, v158, v158 quad_perm:[1,0,3,2] row_mask:0xf bank_mask:0xf
    s_nop 1
    v_add_f32_dpp v158, v158, v158 quad_perm:[2,3,0,1] row_mask:0xf bank_mask:0xf
    s_nop 1
    v_add_f32_dpp v158, v158, v158 row_half_mirror row_mask:0xf bank_mask:0xf
    v_lshrrev_b32 v14, 3, v1
    v_lshlrev_b32 v14, 2, v14
    s_mul_i32 s80, s2, 48
    s_add_u32 s80, s80, 237568
    s_mov_b64 s[98:99], exec
    s_mov_b32 exec_lo, 0x1010101
    s_mov_b32 exec_hi, 0x1010101
    buffer_store_dword v156, v14, s[12:15], s80 offen sc1
    s_mov_b32 exec_hi, 0
    buffer_store_dword v158, v14, s[12:15], s80 offen offset:32 sc1
    s_mov_b64 exec, s[98:99]
L_modf_7:
    v_lshlrev_b32 v14, 7, v1
    s_sub_u32 s82, s5, 5
    s_lshl_b32 s80, s7, 14
    s_lshl_b32 s81, s82, 13
    s_add_u32 s80, s80, s81
    s_cmp_lt_u32 s82, 2
    s_cselect_b64 exec, -1, 0
    buffer_load_dword v15, v14, s[60:63], s80 offen
    s_mov_b64 exec, -1
    ds_read_b64_tr_b16 v[160:161], v7 offset:8
    ds_read_b64_tr_b16 v[162:163], v7 offset:0
    ds_read_b128 v[100:103], v6 offset:256
    ds_read_b128 v[108:111], v6 offset:768
    ds_read_b128 v[116:119], v6 offset:1280
    ds_read_b128 v[124:127], v6 offset:1792
    ds_read_b128 v[132:135], v6 offset:2304
    ds_read_b128 v[140:143], v6 offset:2816
    ds_read_b128 v[148:151], v6 offset:3328
    ds_read_b128 v[156:159], v6 offset:3840
    ds_read_b64_tr_b16 v[164:165], v7 offset:264
    ds_read_b64_tr_b16 v[166:167], v7 offset:256
    ds_read_b128 v[96:99], v6 offset:0
    ds_read_b128 v[104:107], v6 offset:512
    s_waitcnt lgkmcnt(11)
    v_mfma_f32_16x16x32_bf16 v[224:227], v[160:163], v[100:103], 0
    ds_read_b128 v[112:115], v6 offset:1024
    ds_read_b128 v[120:123], v6 offset:1536
    s_waitcnt lgkmcnt(12)
    v_mfma_f32_16x16x32_bf16 v[228:231], v[160:163], v[108:111], 0
    ds_read_b128 v[128:131], v6 offset:2048
    ds_read_b128 v[136:139], v6 offset:2560
    s_waitcnt lgkmcnt(13)
    v_mfma_f32_16x16x32_bf16 v[232:235], v[160:163], v[116:119], 0
    ds_read_b128 v[144:147], v6 offset:3072
    ds_read_b128 v[152:155], v6 offset:3584
    s_waitcnt lgkmcnt(14)
    v_mfma_f32_16x16x32_bf16 v[236:239], v[160:163], v[124:127], 0
    ds_read_b64_tr_b16 v[168:169], v7 offset:520
    ds_read_b64_tr_b16 v[170:171], v7 offset:512
    s_waitcnt lgkmcnt(15)
    v_mfma_f32_16x16x32_bf16 v[240:243], v[160:163], v[132:135], 0
    ds_read_b64_tr_b16 v[172:173], v7 offset:776
    ds_read_b64_tr_b16 v[174:175], v7 offset:768
    s_waitcnt lgkmcnt(15)
    v_mfma_f32_16x16x32_bf16 v[244:247], v[160:163], v[140:143], 0
    ds_read_b64_tr_b16 v[176:177], v7 offset:1032
    ds_read_b64_tr_b16 v[178:179], v7 offset:1024
    v_mfma_f32_16x16x32_bf16 v[248:251], v[160:163], v[148:151], 0
    ds_read_b64_tr_b16 v[180:181], v7 offset:1288
    ds_read_b64_tr_b16 v[182:183], v7 offset:1280
    s_waitcnt lgkmcnt(15)
    v_mfma_f32_16x16x32_bf16 v[252:255], v[160:163], v[156:159], 0
    ds_read_b64_tr_b16 v[184:185], v7 offset:1544
    ds_read_b64_tr_b16 v[186:187], v7 offset:1536
    v_mfma_f32_16x16x32_bf16 v[224:227], v[164:167], v[96:99], v[224:227]
    ds_read_b64_tr_b16 v[188:189], v7 offset:1800
    ds_read_b64_tr_b16 v[190:191], v7 offset:1792
    s_waitcnt lgkmcnt(15)
    v_mfma_f32_16x16x32_bf16 v[228:231], v[164:167], v[104:107], v[228:231]
    ds_read_b64_tr_b16 v[192:193], v7 offset:2056
    ds_read_b64_tr_b16 v[194:195], v7 offset:2048
    v_mfma_f32_16x16x32_bf16 v[232:235], v[164:167], v[112:115], v[232:235]
    ds_read_b64_tr_b16 v[196:197], v7 offset:2312
    ds_read_b64_tr_b16 v[198:199], v7 offset:2304
    v_mfma_f32_16x16x32_bf16 v[236:239], v[164:167], v[120:123], v[236:239]
    ds_read_b64_tr_b16 v[200:201], v7 offset:2568
    ds_read_b64_tr_b16 v[202:203], v7 offset:2560
    v_mfma_f32_16x16x32_bf16 v[240:243], v[164:167], v[128:131], v[240:243]
    ds_read_b64_tr_b16 v[204:205], v7 offset:2824
    ds_read_b64_tr_b16 v[206:207], v7 offset:2816
    s_waitcnt lgkmcnt(15)
    v_mfma_f32_16x16x32_bf16 v[244:247], v[164:167], v[136:139], v[244:247]
    ds_read_b64_tr_b16 v[208:209], v7 offset:3080
    ds_read_b64_tr_b16 v[210:211], v7 offset:3072
    v_mfma_f32_16x16x32_bf16 v[248:251], v[164:167], v[144:147], v[248:251]
    ds_read_b64_tr_b16 v[212:213], v7 offset:3336
    ds_read_b64_tr_b16 v[214:215], v7 offset:3328
    v_mfma_f32_16x16x32_bf16 v[252:255], v[164:167], v[152:155], v[252:255]
    ds_read_b64_tr_b16 v[216:217], v7 offset:3592
    ds_read_b64_tr_b16 v[218:219], v7 offset:3584
    v_mfma_f32_16x16x32_bf16 v[228:231], v[168:171], v[100:103], v[228:231]
    ds_read_b64_tr_b16 v[220:221], v7 offset:3848
    ds_read_b64_tr_b16 v[222:223], v7 offset:3840
    v_mfma_f32_16x16x32_bf16 v[232:235], v[168:171], v[108:111], v[232:235]
    v_mfma_f32_16x16x32_bf16 v[236:239], v[168:171], v[116:119], v[236:239]
    v_mfma_f32_16x16x32_bf16 v[240:243], v[168:171], v[124:127], v[240:243]
    v_mfma_f32_16x16x32_bf16 v[244:247], v[168:171], v[132:135], v[244:247]
    v_mfma_f32_16x16x32_bf16 v[248:251], v[168:171], v[140:143], v[248:251]
    v_mfma_f32_16x16x32_bf16 v[252:255], v[168:171], v[148:151], v[252:255]
    v_mfma_f32_16x16x32_bf16 v[228:231], v[172:175], v[96:99], v[228:231]
    v_mfma_f32_16x16x32_bf16 v[232:235], v[172:175], v[104:107], v[232:235]
    v_mfma_f32_16x16x32_bf16 v[236:239], v[172:175], v[112:115], v[236:239]
    v_mfma_f32_16x16x32_bf16 v[240:243], v[172:175], v[120:123], v[240:243]
    v_mfma_f32_16x16x32_bf16 v[244:247], v[172:175], v[128:131], v[244:247]
    v_mfma_f32_16x16x32_bf16 v[248:251], v[172:175], v[136:139], v[248:251]
    v_mfma_f32_16x16x32_bf16 v[252:255], v[172:175], v[144:147], v[252:255]
    ds_write_b128 v8, v[224:227] offset:0
    s_waitcnt lgkmcnt(15)
    v_mfma_f32_16x16x32_bf16 v[232:235], v[176:179], v[100:103], v[232:235]
    v_mfma_f32_16x16x32_bf16 v[236:239], v[176:179], v[108:111], v[236:239]
    v_mfma_f32_16x16x32_bf16 v[240:243], v[176:179], v[116:119], v[240:243]
    v_mfma_f32_16x16x32_bf16 v[244:247], v[176:179], v[124:127], v[244:247]
    v_mfma_f32_16x16x32_bf16 v[248:251], v[176:179], v[132:135], v[248:251]
    v_mfma_f32_16x16x32_bf16 v[252:255], v[176:179], v[140:143], v[252:255]
    v_mfma_f32_16x16x32_bf16 v[232:235], v[180:183], v[96:99], v[232:235]
    v_mfma_f32_16x16x32_bf16 v[236:239], v[180:183], v[104:107], v[236:239]
    v_mfma_f32_16x16x32_bf16 v[240:243], v[180:183], v[112:115], v[240:243]
    v_mfma_f32_16x16x32_bf16 v[244:247], v[180:183], v[120:123], v[244:247]
    v_mfma_f32_16x16x32_bf16 v[248:251], v[180:183], v[128:131], v[248:251]
    v_mfma_f32_16x16x32_bf16 v[252:255], v[180:183], v[136:139], v[252:255]
    ds_write_b128 v8, v[228:231] offset:1024
    v_mfma_f32_16x16x32_bf16 v[236:239], v[184:187], v[100:103], v[236:239]
    v_mfma_f32_16x16x32_bf16 v[240:243], v[184:187], v[108:111], v[240:243]
    v_mfma_f32_16x16x32_bf16 v[244:247], v[184:187], v[116:119], v[244:247]
    v_mfma_f32_16x16x32_bf16 v[248:251], v[184:187], v[124:127], v[248:251]
    v_mfma_f32_16x16x32_bf16 v[252:255], v[184:187], v[132:135], v[252:255]
    v_mfma_f32_16x16x32_bf16 v[236:239], v[188:191], v[96:99], v[236:239]
    v_mfma_f32_16x16x32_bf16 v[240:243], v[188:191], v[104:107], v[240:243]
    v_mfma_f32_16x16x32_bf16 v[244:247], v[188:191], v[112:115], v[244:247]
    v_mfma_f32_16x16x32_bf16 v[248:251], v[188:191], v[120:123], v[248:251]
    v_mfma_f32_16x16x32_bf16 v[252:255], v[188:191], v[128:131], v[252:255]
    ds_write_b128 v8, v[232:235] offset:2048
    v_mfma_f32_16x16x32_bf16 v[240:243], v[192:195], v[100:103], v[240:243]
    v_mfma_f32_16x16x32_bf16 v[244:247], v[192:195], v[108:111], v[244:247]
    v_mfma_f32_16x16x32_bf16 v[248:251], v[192:195], v[116:119], v[248:251]
    v_mfma_f32_16x16x32_bf16 v[252:255], v[192:195], v[124:127], v[252:255]
    s_waitcnt lgkmcnt(15)
    v_mfma_f32_16x16x32_bf16 v[240:243], v[196:199], v[96:99], v[240:243]
    v_mfma_f32_16x16x32_bf16 v[244:247], v[196:199], v[104:107], v[244:247]
    v_mfma_f32_16x16x32_bf16 v[248:251], v[196:199], v[112:115], v[248:251]
    v_mfma_f32_16x16x32_bf16 v[252:255], v[196:199], v[120:123], v[252:255]
    ds_write_b128 v8, v[236:239] offset:3072
    s_waitcnt lgkmcnt(14)
    v_mfma_f32_16x16x32_bf16 v[244:247], v[200:203], v[100:103], v[244:247]
    v_mfma_f32_16x16x32_bf16 v[248:251], v[200:203], v[108:111], v[248:251]
    v_mfma_f32_16x16x32_bf16 v[252:255], v[200:203], v[116:119], v[252:255]
    s_waitcnt lgkmcnt(12)
    v_mfma_f32_16x16x32_bf16 v[244:247], v[204:207], v[96:99], v[244:247]
    v_mfma_f32_16x16x32_bf16 v[248:251], v[204:207], v[104:107], v[248:251]
    v_mfma_f32_16x16x32_bf16 v[252:255], v[204:207], v[112:115], v[252:255]
    ds_write_b128 v8, v[240:243] offset:4096
    s_waitcnt lgkmcnt(11)
    v_mfma_f32_16x16x32_bf16 v[248:251], v[208:211], v[100:103], v[248:251]
    v_mfma_f32_16x16x32_bf16 v[252:255], v[208:211], v[108:111], v[252:255]
    s_waitcnt lgkmcnt(9)
    v_mfma_f32_16x16x32_bf16 v[248:251], v[212:215], v[96:99], v[248:251]
    v_mfma_f32_16x16x32_bf16 v[252:255], v[212:215], v[104:107], v[252:255]
    s_cmp_ge_u32 s5, 4
    s_cbranch_scc1 L_swzfin_10
    s_waitcnt vmcnt(0)
    v_lshrrev_b32 v46, 2, v2
    v_lshl_add_u32 v46, v3, 3, v46
    v_lshlrev_b32 v46, 7, v46
    v_and_b32 v47, 3, v2
    v_lshl_add_u32 v46, v47, 3, v46
    v_add_u32 v46, s97, v46
    ds_read_b64_tr_b16 v[48:49], v46 offset:0
    ds_read_b64_tr_b16 v[50:51], v46 offset:512
    ds_read_b64_tr_b16 v[52:53], v46 offset:32
    ds_read_b64_tr_b16 v[54:55], v46 offset:544
    ds_read_b64_tr_b16 v[56:57], v46 offset:64
    ds_read_b64_tr_b16 v[58:59], v46 offset:576
    ds_read_b64_tr_b16 v[60:61], v46 offset:96
    ds_read_b64_tr_b16 v[62:63], v46 offset:608
    s_waitcnt lgkmcnt(0)
    s_mov_b32 s80, s90
    s_mov_b32 s81, 0x7ff00000
    s_cmp_gt_u32 s91, 0
    s_cselect_b32 s82, s80, s81
    buffer_store_dwordx4 v[48:51], v4, s[12:15], s82 offen sc1
    s_add_u32 s80, s80, s96
    s_cmp_gt_u32 s91, 1
    s_cselect_b32 s82, s80, s81
    buffer_store_dwordx4 v[52:55], v4, s[12:15], s82 offen sc1
    s_add_u32 s80, s80, s96
    s_cmp_gt_u32 s91, 2
    s_cselect_b32 s82, s80, s81
    buffer_store_dwordx4 v[56:59], v4, s[12:15], s82 offen sc1
    s_add_u32 s80, s80, s96
    s_cmp_gt_u32 s91, 3
    s_cselect_b32 s82, s80, s81
    buffer_store_dwordx4 v[60:63], v4, s[12:15], s82 offen sc1
    s_add_u32 s80, s80, s96
L_swzfin_10:
    ds_write_b128 v8, v[244:247] offset:5120
    s_waitcnt lgkmcnt(8)
    v_mfma_f32_16x16x32_bf16 v[252:255], v[216:219], v[100:103], v[252:255]
    s_waitcnt lgkmcnt(6)
    v_mfma_f32_16x16x32_bf16 v[252:255], v[220:223], v[96:99], v[252:255]
    ds_write_b128 v8, v[248:251] offset:6144
    s_nop 6
    ds_write_b128 v8, v[252:255] offset:7168
    s_waitcnt lgkmcnt(0)
    s_barrier
    s_lshl_b32 s80, s5, 10
    v_add_u32 v23, s80, v4
    ds_read_b128 v[96:99], v23 offset:0
    ds_read_b128 v[100:103], v23 offset:8192
    ds_read_b128 v[104:107], v23 offset:16384
    ds_read_b128 v[108:111], v23 offset:24576
    ds_read_b128 v[112:115], v23 offset:32768
    ds_read_b128 v[116:119], v23 offset:40960
    ds_read_b128 v[120:123], v23 offset:49152
    ds_read_b128 v[124:127], v23 offset:57344
    ds_read_b128 v[128:131], v11
    ds_read_b64 v[136:137], v12
    ds_read_b64 v[138:139], v12 offset:4672
    s_lshl_b32 s80, s5, 18
    s_lshl_b32 s81, s76, 6
    s_add_u32 s80, s80, s81
    s_add_u32 s87, s80, 393216
    s_waitcnt vmcnt(0)
    v_lshlrev_b32 v77, 16, v76
    v_and_b32 v76, 0xffff0000, v76
    s_waitcnt lgkmcnt(0)
    v_pk_add_f32 v[96:97], v[96:97], v[100:101]
    v_pk_add_f32 v[104:105], v[104:105], v[108:109]
    v_pk_add_f32 v[96:97], v[96:97], v[104:105]
    v_pk_add_f32 v[98:99], v[98:99], v[102:103]
    v_pk_add_f32 v[106:107], v[106:107], v[110:111]
    v_pk_add_f32 v[98:99], v[98:99], v[106:107]
    v_lshlrev_b32 v40, 16, v136
    v_and_b32 v42, 0xffff0000, v136
    v_lshlrev_b32 v44, 16, v137
    v_and_b32 v46, 0xffff0000, v137
    v_lshlrev_b32 v41, 16, v128
    v_lshlrev_b32 v43, 16, v129
    v_lshlrev_b32 v45, 16, v130
    v_lshlrev_b32 v47, 16, v131
    v_fma_f32 v96, v40, v77, v96
    v_fma_f32 v97, v42, v77, v97
    v_fma_f32 v98, v44, v77, v98
    v_fma_f32 v99, v46, v77, v99
    v_fma_f32 v96, v68, v96, v41
    v_fma_f32 v97, v68, v97, v43
    v_fma_f32 v98, v68, v98, v45
    v_fma_f32 v99, v68, v99, v47
    v_cvt_pk_bf16_f32 v28, v96, v97
    v_cvt_pk_bf16_f32 v29, v98, v99
    v_pk_add_f32 v[112:113], v[112:113], v[116:117]
    v_pk_add_f32 v[120:121], v[120:121], v[124:125]
    v_pk_add_f32 v[112:113], v[112:113], v[120:121]
    v_pk_add_f32 v[114:115], v[114:115], v[118:119]
    v_pk_add_f32 v[122:123], v[122:123], v[126:127]
    v_pk_add_f32 v[114:115], v[114:115], v[122:123]
    v_lshlrev_b32 v40, 16, v138
    v_and_b32 v42, 0xffff0000, v138
    v_lshlrev_b32 v44, 16, v139
    v_and_b32 v46, 0xffff0000, v139
    v_and_b32 v41, 0xffff0000, v128
    v_and_b32 v43, 0xffff0000, v129
    v_and_b32 v45, 0xffff0000, v130
    v_and_b32 v47, 0xffff0000, v131
    v_fma_f32 v112, v40, v76, v112
    v_fma_f32 v113, v42, v76, v113
    v_fma_f32 v114, v44, v76, v114
    v_fma_f32 v115, v46, v76, v115
    v_fma_f32 v112, v70, v112, v41
    v_fma_f32 v113, v70, v113, v43
    v_fma_f32 v114, v70, v114, v45
    v_fma_f32 v115, v70, v115, v47
    v_cvt_pk_bf16_f32 v30, v112, v113
    v_cvt_pk_bf16_f32 v31, v114, v115
    s_nop 0
    v_permlane16_swap_b32 v28, v30
    v_permlane16_swap_b32 v29, v31
    buffer_store_dwordx4 v[28:31], v13, s[12:15], s87 offen sc1
    s_waitcnt vmcnt(0)
    s_barrier
    s_lshl_b32 s80, s2, 6
    s_add_u32 s80, s80, 278528
    v_mov_b32 v14, s4
    v_mov_b32 v15, 0
    s_cmp_eq_u32 s5, 0
    s_cselect_b64 exec, 1, 0
    buffer_store_dword v14, v15, s[12:15], s80 offen sc1
    s_mov_b64 exec, -1
    v_and_b32 v15, 3, v2
    v_cmp_eq_u32 s[90:91], 1, v15
    v_cmp_eq_u32 s[92:93], 2, v15
    v_cmp_eq_u32 s[94:95], 3, v15
    v_lshrrev_b32 v14, 2, v2
    v_cmp_eq_u32 s[96:97], v14, v3
    v_mov_b32 v16, 0x3f803f80
    v_mov_b32 v17, 0x3f803f80
    v_mov_b32 v18, 0x3f803f80
    v_mov_b32 v19, 0x3f803f80
    s_and_b32 s85, s5, 1
    s_lshr_b32 s86, s5, 1
    v_lshrrev_b32 v24, 5, v1
    v_lshlrev_b32 v24, 5, v24
    v_xor_b32 v24, v24, v4
    v_lshrrev_b32 v14, 2, v2
    v_lshl_add_u32 v25, v3, 3, v14
    v_lshlrev_b32 v25, 6, v25
    v_and_b32 v14, 3, v2
    v_lshl_add_u32 v25, v14, 3, v25
    v_and_b32 v14, 1, v3
    v_xor_b32 v14, s85, v14
    v_lshl_add_u32 v25, v14, 5, v25
    s_lshl_b32 s80, s86, 13
    v_add_u32 v25, s80, v25
    s_lshl_b32 s80, s86, 9
    s_add_u32 s80, s80, 122880
    v_lshl_add_u32 v26, v3, 5, s80
    s_lshl_b32 s80, s5, 7
    s_add_u32 s80, s80, 126976
    v_lshl_add_u32 v27, v2, 3, s80
    s_lshl_b32 s80, s85, 7
    s_add_u32 s80, s80, 126976
    v_lshl_add_u32 v28, v2, 3, s80
    s_lshl_b32 s80, s86, 13
    s_lshl_b32 s81, s85, 10
    s_add_u32 s80, s80, s81
    s_add_u32 s80, s80, 32768
    v_add_u32 v29, s80, v4
    v_add_u32 v30, 32768, v4
    v_lshrrev_b32 v32, 4, v1
    v_lshlrev_b32 v32, 10, v32
    v_and_b32 v33, 15, v1
    v_lshrrev_b32 v34, 1, v33
    v_lshrrev_b32 v35, 4, v1
    v_xor_b32 v34, v34, v35
    v_and_b32 v33, 1, v33
    v_lshlrev_b32 v33, 4, v33
    v_lshl_add_u32 v36, v34, 5, v33
    v_add_u32 v36, v36, v32
    v_xor_b32 v34, 4, v34
    v_lshl_add_u32 v37, v34, 5, v33
    v_add_u32 v37, v37, v32
    s_lshr_b32 s80, s5, 1
    s_and_b32 s80, s80, 1
    s_cmp_eq_u32 s80, 1
    s_cselect_b64 vcc, -1, 0
    v_cndmask_b32 v36, v36, v37, vcc
    s_lshl_b32 s80, s5, 12
    s_lshl_b32 s81, s101, 8
    s_add_u32 s80, s80, s81
    s_lshl_b32 s81, s5, 10
    s_add_u32 s81, s81, 32768
    s_mov_b32 m0, s81
    s_nop 0
    buffer_load_dwordx4 v36, s[60:63], s80 offen lds
    s_add_u32 s80, s80, 32768
    s_add_u32 s81, s81, 8192
    s_mov_b32 m0, s81
    s_nop 0
    buffer_load_dwordx4 v36, s[60:63], s80 offen lds
    s_add_u32 s80, s80, 32768
    s_add_u32 s81, s81, 8192
    s_mov_b32 m0, s81
    s_nop 0
    buffer_load_dwordx4 v36, s[60:63], s80 offen lds
    s_add_u32 s80, s80, 32768
    s_add_u32 s81, s81, 8192
    s_mov_b32 m0, s81
    s_nop 0
    buffer_load_dwordx4 v36, s[60:63], s80 offen lds
    s_add_u32 s80, s80, 32768
    s_add_u32 s81, s81, 8192
    s_mov_b32 m0, s81
    s_nop 0
    buffer_load_dwordx4 v36, s[60:63], s80 offen lds
    s_add_u32 s80, s80, 32768
    s_add_u32 s81, s81, 8192
    s_mov_b32 m0, s81
    s_nop 0
    buffer_load_dwordx4 v36, s[60:63], s80 offen lds
    s_add_u32 s80, s80, 32768
    s_add_u32 s81, s81, 8192
    s_mov_b32 m0, s81
    s_nop 0
    buffer_load_dwordx4 v36, s[60:63], s80 offen lds
    s_add_u32 s80, s80, 32768
    s_add_u32 s81, s81, 8192
    s_mov_b32 m0, s81
    s_nop 0
    buffer_load_dwordx4 v36, s[60:63], s80 offen lds
    s_add_u32 s80, s80, 32768
    s_add_u32 s81, s81, 8192
    s_mov_b32 m0, s81
    s_nop 0
    buffer_load_dwordx4 v36, s[60:63], s80 offen lds
    s_add_u32 s80, s80, 32768
    s_add_u32 s81, s81, 8192
    s_mov_b32 m0, s81
    s_nop 0
    buffer_load_dwordx4 v36, s[60:63], s80 offen lds
    s_add_u32 s80, s80, 32768
    s_add_u32 s81, s81, 8192
    s_mov_b32 m0, s81
    s_nop 0
    buffer_load_dwordx4 v36, s[60:63], s80 offen lds
    s_add_u32 s80, s80, 32768
    s_add_u32 s81, s81, 8192
    s_mov_b32 m0, s81
    s_nop 0
    buffer_load_dwordx4 v36, s[60:63], s80 offen lds
    s_add_u32 s80, s80, 32768
    s_add_u32 s81, s81, 8192
    s_mov_b32 m0, s81
    s_nop 0
    buffer_load_dwordx4 v36, s[60:63], s80 offen lds
    s_add_u32 s80, s80, 32768
    s_add_u32 s81, s81, 8192
    s_mov_b32 m0, s81
    s_nop 0
    buffer_load_dwordx4 v36, s[60:63], s80 offen lds
    s_add_u32 s80, s80, 32768
    s_add_u32 s81, s81, 8192
    s_mov_b32 m0, s81
    s_nop 0
    buffer_load_dwordx4 v36, s[60:63], s80 offen lds
    s_add_u32 s80, s80, 32768
    s_add_u32 s81, s81, 8192
    s_mov_b32 m0, s81
    s_nop 0
    buffer_load_dwordx4 v36, s[60:63], s80 offen lds
    v_lshrrev_b32 v33, 2, v2
    v_and_b32 v34, 1, v3
    v_lshl_or_b32 v34, v34, 2, v33
    v_xor_b32 v34, s5, v34
    v_lshl_add_u32 v35, v3, 3, v33
    v_lshlrev_b32 v35, 8, v35
    v_lshl_add_u32 v35, v34, 5, v35
    v_and_b32 v33, 3, v2
    v_lshl_add_u32 v35, v33, 3, v35
    v_add_u32 v35, 32768, v35
    v_add_u32 v37, 65536, v35
    v_lshrrev_b32 v14, 5, v1
    v_mul_u32_u24 v14, 768, v14
    v_and_b32 v15, 31, v1
    v_lshl_add_u32 v14, v15, 4, v14
    s_mul_i32 s80, s100, 49152
    s_lshl_b32 s81, s101, 3
    s_add_u32 s81, s81, s5
    s_mul_i32 s81, s81, 1536
    s_add_u32 s80, s80, s81
    s_add_u32 s80, s80, 2490496
    v_add_u32 v12, s80, v14
    s_cmp_eq_u32 s100, 0
    s_mov_b32 s80, 0xffff4200
    s_cmp_eq_u32 s100, 0
    s_cselect_b32 s80, -32, s80
    s_cselect_b32 s70, 3, 0
    s_mov_b32 s81, 48640
    s_cmp_eq_u32 s100, 63
    s_cselect_b32 s81, 32, s81
    s_cselect_b32 s70, 0xc0000000, s70
    s_mov_b32 s71, s70
    v_cmp_gt_u32 vcc, 2, v15
    v_mov_b32 v14, s81
    v_mov_b32 v15, s80
    v_cndmask_b32 v14, v14, v15, vcc
    v_add_u32 v13, v12, v14
    v_mov_b32 v31, 0
    s_cmp_eq_u32 s5, 7
    s_cbranch_scc1 L_slabw_11
    s_waitcnt vmcnt(0)
L_slabw_11:
    s_cmp_lg_u32 s5, 7
    s_cbranch_scc1 L_pollskip_12
    v_lshlrev_b32 v116, 6, v1
    s_mov_b32 s84, 0
L_poll_13:
    s_mov_b32 s81, 278528
    buffer_load_dword v118, v116, s[12:15], s81 offen sc1
    s_mov_b32 s81, 282624
    buffer_load_dword v119, v116, s[12:15], s81 offen sc1
    s_mov_b32 s81, 286720
    buffer_load_dword v120, v116, s[12:15], s81 offen sc1
    s_mov_b32 s81, 290816
    buffer_load_dword v121, v116, s[12:15], s81 offen sc1
    s_waitcnt vmcnt(0)
    v_min3_u32 v122, v118, v119, v120
    v_max3_u32 v123, v118, v119, v120
    v_min3_u32 v122, v122, v121, v121
    v_max3_u32 v123, v123, v121, v121
    v_cmp_ne_u32 vcc, s4, v122
    v_cmp_ne_u32 s[98:99], s4, v123
    s_nop 0
    s_or_b64 vcc, vcc, s[98:99]
    s_cbranch_vccz L_pollok_14
    s_add_u32 s84, s84, 1
    s_cmp_lt_u32 s84, 20000
    s_cbranch_scc1 L_poll_13
L_pollok_14:
L_pollskip_12:
    s_barrier
    s_lshl_b32 s80, s100, 15
    s_lshl_b32 s81, s5, 10
    s_add_u32 s80, s80, s81
    s_add_u32 s80, s80, 393216
    s_add_u32 s83, s81, 0
    s_mov_b32 m0, s83
    s_nop 0
    buffer_load_dwordx4 v24, s[12:15], s80 offen sc1 lds
    s_add_u32 s80, s80, 8192
    s_add_u32 s83, s81, 8192
    s_mov_b32 m0, s83
    s_nop 0
    buffer_load_dwordx4 v24, s[12:15], s80 offen sc1 lds
    s_add_u32 s80, s80, 8192
    s_add_u32 s83, s81, 16384
    s_mov_b32 m0, s83
    s_nop 0
    buffer_load_dwordx4 v24, s[12:15], s80 offen sc1 lds
    s_add_u32 s80, s80, 8192
    s_add_u32 s83, s81, 24576
    s_mov_b32 m0, s83
    s_nop 0
    buffer_load_dwordx4 v24, s[12:15], s80 offen sc1 lds
    v_lshlrev_b32 v14, 2, v0
    s_mov_b32 s80, 245760
    buffer_load_dword v38, v14, s[12:15], s80 offen sc1
    s_mov_b32 s80, 243712
    buffer_load_dword v39, v14, s[12:15], s80 offen sc1
    ds_read_b64_tr_b16 v[128:129], v35 offset:0
    ds_read_b64_tr_b16 v[130:131], v35 offset:1024
    ds_read_b64_tr_b16 v[132:133], v35 offset:8192
    ds_read_b64_tr_b16 v[134:135], v35 offset:9216
    ds_read_b64_tr_b16 v[136:137], v35 offset:16384
    ds_read_b64_tr_b16 v[138:139], v35 offset:17408
    ds_read_b64_tr_b16 v[140:141], v35 offset:24576
    ds_read_b64_tr_b16 v[142:143], v35 offset:25600
    ds_read_b64_tr_b16 v[144:145], v35 offset:32768
    ds_read_b64_tr_b16 v[146:147], v35 offset:33792
    ds_read_b64_tr_b16 v[148:149], v35 offset:40960
    ds_read_b64_tr_b16 v[150:151], v35 offset:41984
    ds_read_b64_tr_b16 v[152:153], v35 offset:49152
    ds_read_b64_tr_b16 v[154:155], v35 offset:50176
    ds_read_b64_tr_b16 v[156:157], v35 offset:57344
    ds_read_b64_tr_b16 v[158:159], v35 offset:58368
    ds_read_b64_tr_b16 v[160:161], v37 offset:0
    ds_read_b64_tr_b16 v[162:163], v37 offset:1024
    ds_read_b64_tr_b16 v[164:165], v37 offset:8192
    ds_read_b64_tr_b16 v[166:167], v37 offset:9216
    ds_read_b64_tr_b16 v[168:169], v37 offset:16384
    ds_read_b64_tr_b16 v[170:171], v37 offset:17408
    ds_read_b64_tr_b16 v[172:173], v37 offset:24576
    ds_read_b64_tr_b16 v[174:175], v37 offset:25600
    ds_read_b64_tr_b16 v[176:177], v37 offset:32768
    ds_read_b64_tr_b16 v[178:179], v37 offset:33792
    ds_read_b64_tr_b16 v[180:181], v37 offset:40960
    ds_read_b64_tr_b16 v[182:183], v37 offset:41984
    ds_read_b64_tr_b16 v[184:185], v37 offset:49152
    ds_read_b64_tr_b16 v[186:187], v37 offset:50176
    ds_read_b64_tr_b16 v[188:189], v37 offset:57344
    ds_read_b64_tr_b16 v[190:191], v37 offset:58368
    v_lshlrev_b32 v15, 2, v0
    v_add_u32 v15, 122880, v15
    s_waitcnt lgkmcnt(0)
    v_mfma_f32_16x16x32_bf16 v[20:23], v[128:131], v[16:19], 0
    v_mfma_f32_16x16x32_bf16 v[32:35], v[132:135], v[16:19], 0
    v_mfma_f32_16x16x32_bf16 v[20:23], v[136:139], v[16:19], v[20:23]
    v_mfma_f32_16x16x32_bf16 v[32:35], v[140:143], v[16:19], v[32:35]
    v_mfma_f32_16x16x32_bf16 v[20:23], v[144:147], v[16:19], v[20:23]
    v_mfma_f32_16x16x32_bf16 v[32:35], v[148:151], v[16:19], v[32:35]
    v_mfma_f32_16x16x32_bf16 v[20:23], v[152:155], v[16:19], v[20:23]
    v_mfma_f32_16x16x32_bf16 v[32:35], v[156:159], v[16:19], v[32:35]
    v_mfma_f32_16x16x32_bf16 v[20:23], v[160:163], v[16:19], v[20:23]
    v_mfma_f32_16x16x32_bf16 v[32:35], v[164:167], v[16:19], v[32:35]
    v_mfma_f32_16x16x32_bf16 v[20:23], v[168:171], v[16:19], v[20:23]
    v_mfma_f32_16x16x32_bf16 v[32:35], v[172:175], v[16:19], v[32:35]
    v_mfma_f32_16x16x32_bf16 v[20:23], v[176:179], v[16:19], v[20:23]
    v_mfma_f32_16x16x32_bf16 v[32:35], v[180:183], v[16:19], v[32:35]
    v_mfma_f32_16x16x32_bf16 v[20:23], v[184:187], v[16:19], v[20:23]
    v_mfma_f32_16x16x32_bf16 v[32:35], v[188:191], v[16:19], v[32:35]
    s_nop 7
    v_add_f32 v20, v20, v32
    v_add_f32 v21, v21, v33
    v_add_f32 v22, v22, v34
    v_add_f32 v23, v23, v35
    s_waitcnt vmcnt(0)
    v_add_f32 v38, 1.0, v38
    s_barrier
    ds_write_b32 v15, v38
    ds_write_b32 v15, v39 offset:2048
    s_lshl_b32 s80, s77, 16
    s_lshr_b32 s81, s5, 2
    s_lshl_b32 s81, s81, 15
    s_add_u32 s80, s80, s81
    s_lshl_b32 s81, s78, 12
    s_add_u32 s80, s80, s81
    s_and_b32 s81, s5, 3
    s_lshl_b32 s81, s81, 10
    s_add_u32 s80, s80, s81
    s_add_u32 s80, s80, 393216
    s_lshl_b32 s81, s5, 10
    s_add_u32 s81, s81, 114688
    s_mov_b32 m0, s81
    s_nop 0
    buffer_load_dwordx4 v4, s[12:15], s80 offen sc1 lds
    s_lshl_b32 s88, s101, 3
    s_add_u32 s88, s88, s5
    s_mul_i32 s88, s88, 16384
    s_add_u32 s88, s88, 13893632
    ds_read_b64_tr_b16 v[32:33], v25 offset:0
    ds_read_b64_tr_b16 v[34:35], v25 offset:256
    ds_read_b64_tr_b16 v[36:37], v25 offset:2048
    ds_read_b64_tr_b16 v[38:39], v25 offset:2304
    ds_read_b64_tr_b16 v[40:41], v25 offset:4096
    ds_read_b64_tr_b16 v[42:43], v25 offset:4352
    ds_read_b64_tr_b16 v[44:45], v25 offset:6144
    ds_read_b64_tr_b16 v[46:47], v25 offset:6400
    s_waitcnt lgkmcnt(6)
    v_mfma_f32_16x16x32_bf16 v[48:51], v[16:19], v[32:35], 0
    v_mfma_f32_16x16x32_bf16 v[52:55], v[32:35], v[32:35], 0
    buffer_load_dwordx4 v[192:195], v4, s[12:15], s88 offen sc1
    s_waitcnt lgkmcnt(4)
    v_mfma_f32_16x16x32_bf16 v[48:51], v[16:19], v[36:39], v[48:51]
    v_mfma_f32_16x16x32_bf16 v[52:55], v[36:39], v[36:39], v[52:55]
    buffer_load_dwordx4 v[196:199], v4, s[12:15], s88 offen offset:1024 sc1
    s_waitcnt lgkmcnt(2)
    v_mfma_f32_16x16x32_bf16 v[48:51], v[16:19], v[40:43], v[48:51]
    v_mfma_f32_16x16x32_bf16 v[52:55], v[40:43], v[40:43], v[52:55]
    buffer_load_dwordx4 v[200:203], v4, s[12:15], s88 offen offset:2048 sc1
    s_waitcnt lgkmcnt(0)
    v_mfma_f32_16x16x32_bf16 v[48:51], v[16:19], v[44:47], v[48:51]
    v_mfma_f32_16x16x32_bf16 v[52:55], v[44:47], v[44:47], v[52:55]
    buffer_load_dwordx4 v[204:207], v4, s[12:15], s88 offen offset:3072 sc1
    s_nop 6
    v_cndmask_b32 v57, v52, v53, s[90:91]
    v_mov_b32 v56, v48
    v_cndmask_b32 v57, v57, v54, s[92:93]
    v_cndmask_b32 v57, v57, v55, s[94:95]
    s_mov_b64 s[98:99], exec
    s_mov_b64 exec, s[96:97]
    ds_write_b64 v27, v[56:57]
    s_mov_b64 exec, s[98:99]
    s_waitcnt lgkmcnt(0)
    s_barrier
    ds_read_b64 v[48:49], v28
    ds_read_b64 v[50:51], v28 offset:256
    ds_read_b64 v[52:53], v28 offset:512
    ds_read_b64 v[54:55], v28 offset:768
    ds_read_b128 v[64:67], v26 offset:0
    ds_read_b128 v[68:71], v26 offset:16
    ds_read_b128 v[72:75], v26 offset:2048
    ds_read_b128 v[76:79], v26 offset:2064
    ds_read_b128 v[80:83], v26 offset:128
    ds_read_b128 v[84:87], v26 offset:144
    ds_read_b128 v[88:91], v26 offset:2176
    ds_read_b128 v[92:95], v26 offset:2192
    s_waitcnt lgkmcnt(8)
    ds_read_b128 v[96:99], v26 offset:256
    ds_read_b128 v[100:103], v26 offset:272
    ds_read_b128 v[104:107], v26 offset:2304
    ds_read_b128 v[108:111], v26 offset:2320
    ds_read_b128 v[112:115], v26 offset:384
    ds_read_b128 v[116:119], v26 offset:400
    ds_read_b128 v[120:123], v26 offset:2432
    ds_read_b128 v[124:127], v26 offset:2448
    v_pk_add_f32 v[48:49], v[48:49], v[50:51]
    v_pk_add_f32 v[52:53], v[52:53], v[54:55]
    v_pk_add_f32 v[48:49], v[48:49], v[52:53]
    v_mul_f32 v58, 0x3b000000, v48
    v_mul_f32 v56, 0x3b000000, v49
    v_fma_f32 v56, -v58, v58, v56
    v_max_f32 v56, 0, v56
    v_add_f32 v56, 0x3727c5ac, v56
    v_rsq_f32 v56, v56
    s_nop 0
    v_mul_f32 v58, v58, v56
    s_waitcnt lgkmcnt(12)
    v_lshlrev_b32 v60, 16, v32
    v_lshlrev_b32 v62, 16, v33
    v_lshlrev_b32 v8, 16, v34
    v_lshlrev_b32 v10, 16, v35
    v_and_b32 v61, 0xffff0000, v32
    v_and_b32 v63, 0xffff0000, v33
    v_and_b32 v9, 0xffff0000, v34
    v_and_b32 v11, 0xffff0000, v35
    v_pk_fma_f32 v[60:61], v[60:61], v[56:57], v[58:59] op_sel_hi:[1,0,0] neg_lo:[0,0,1] neg_hi:[0,0,1]
    v_pk_fma_f32 v[62:63], v[62:63], v[56:57], v[58:59] op_sel_hi:[1,0,0] neg_lo:[0,0,1] neg_hi:[0,0,1]
    v_pk_fma_f32 v[8:9], v[8:9], v[56:57], v[58:59] op_sel_hi:[1,0,0] neg_lo:[0,0,1] neg_hi:[0,0,1]
    v_pk_fma_f32 v[10:11], v[10:11], v[56:57], v[58:59] op_sel_hi:[1,0,0] neg_lo:[0,0,1] neg_hi:[0,0,1]
    v_pk_fma_f32 v[60:61], v[60:61], v[64:65], v[72:73]
    v_pk_fma_f32 v[62:63], v[62:63], v[66:67], v[74:75]
    v_pk_fma_f32 v[8:9], v[8:9], v[68:69], v[76:77]
    v_pk_fma_f32 v[10:11], v[10:11], v[70:71], v[78:79]
    v_cvt_pk_bf16_f32 v32, v60, v61
    v_cvt_pk_bf16_f32 v33, v62, v63
    v_cvt_pk_bf16_f32 v34, v8, v9
    v_cvt_pk_bf16_f32 v35, v10, v11
    s_add_u32 s88, s88, 4096
    buffer_load_dwordx4 v[208:211], v4, s[12:15], s88 offen sc1
    ds_write_b128 v29, v[32:35] offset:0
    s_waitcnt lgkmcnt(9)
    v_lshlrev_b32 v60, 16, v36
    v_lshlrev_b32 v62, 16, v37
    v_lshlrev_b32 v8, 16, v38
    v_lshlrev_b32 v10, 16, v39
    v_and_b32 v61, 0xffff0000, v36
    v_and_b32 v63, 0xffff0000, v37
    v_and_b32 v9, 0xffff0000, v38
    v_and_b32 v11, 0xffff0000, v39
    v_pk_fma_f32 v[60:61], v[60:61], v[56:57], v[58:59] op_sel_hi:[1,0,0] neg_lo:[0,0,1] neg_hi:[0,0,1]
    v_pk_fma_f32 v[62:63], v[62:63], v[56:57], v[58:59] op_sel_hi:[1,0,0] neg_lo:[0,0,1] neg_hi:[0,0,1]
    v_pk_fma_f32 v[8:9], v[8:9], v[56:57], v[58:59] op_sel_hi:[1,0,0] neg_lo:[0,0,1] neg_hi:[0,0,1]
    v_pk_fma_f32 v[10:11], v[10:11], v[56:57], v[58:59] op_sel_hi:[1,0,0] neg_lo:[0,0,1] neg_hi:[0,0,1]
    v_pk_fma_f32 v[60:61], v[60:61], v[80:81], v[88:89]
    v_pk_fma_f32 v[62:63], v[62:63], v[82:83], v[90:91]
    v_pk_fma_f32 v[8:9], v[8:9], v[84:85], v[92:93]
    v_pk_fma_f32 v[10:11], v[10:11], v[86:87], v[94:95]
    v_cvt_pk_bf16_f32 v36, v60, v61
    v_cvt_pk_bf16_f32 v37, v62, v63
    v_cvt_pk_bf16_f32 v38, v8, v9
    v_cvt_pk_bf16_f32 v39, v10, v11
    buffer_load_dwordx4 v[212:215], v4, s[12:15], s88 offen offset:1024 sc1
    ds_write_b128 v29, v[36:39] offset:2048
    v_mfma_f32_16x16x32_bf16 v[48:51], v[16:19], v[32:35], 0
    v_mfma_f32_16x16x32_bf16 v[52:55], v[32:35], v[32:35], 0
    s_waitcnt lgkmcnt(6)
    v_lshlrev_b32 v60, 16, v40
    v_lshlrev_b32 v62, 16, v41
    v_lshlrev_b32 v8, 16, v42
    v_lshlrev_b32 v10, 16, v43
    v_and_b32 v61, 0xffff0000, v40
    v_and_b32 v63, 0xffff0000, v41
    v_and_b32 v9, 0xffff0000, v42
    v_and_b32 v11, 0xffff0000, v43
    v_pk_fma_f32 v[60:61], v[60:61], v[56:57], v[58:59] op_sel_hi:[1,0,0] neg_lo:[0,0,1] neg_hi:[0,0,1]
    v_pk_fma_f32 v[62:63], v[62:63], v[56:57], v[58:59] op_sel_hi:[1,0,0] neg_lo:[0,0,1] neg_hi:[0,0,1]
    v_pk_fma_f32 v[8:9], v[8:9], v[56:57], v[58:59] op_sel_hi:[1,0,0] neg_lo:[0,0,1] neg_hi:[0,0,1]
    v_pk_fma_f32 v[10:11], v[10:11], v[56:57], v[58:59] op_sel_hi:[1,0,0] neg_lo:[0,0,1] neg_hi:[0,0,1]
    v_pk_fma_f32 v[60:61], v[60:61], v[96:97], v[104:105]
    v_pk_fma_f32 v[62:63], v[62:63], v[98:99], v[106:107]
    v_pk_fma_f32 v[8:9], v[8:9], v[100:101], v[108:109]
    v_pk_fma_f32 v[10:11], v[10:11], v[102:103], v[110:111]
    v_cvt_pk_bf16_f32 v40, v60, v61
    v_cvt_pk_bf16_f32 v41, v62, v63
    v_cvt_pk_bf16_f32 v42, v8, v9
    v_cvt_pk_bf16_f32 v43, v10, v11
    buffer_load_dwordx4 v[216:219], v4, s[12:15], s88 offen offset:2048 sc1
    ds_write_b128 v29, v[40:43] offset:4096
    v_mfma_f32_16x16x32_bf16 v[48:51], v[16:19], v[36:39], v[48:51]
    v_mfma_f32_16x16x32_bf16 v[52:55], v[36:39], v[36:39], v[52:55]
    s_waitcnt lgkmcnt(3)
    v_lshlrev_b32 v60, 16, v44
    v_lshlrev_b32 v62, 16, v45
    v_lshlrev_b32 v8, 16, v46
    v_lshlrev_b32 v10, 16, v47
    v_and_b32 v61, 0xffff0000, v44
    v_and_b32 v63, 0xffff0000, v45
    v_and_b32 v9, 0xffff0000, v46
    v_and_b32 v11, 0xffff0000, v47
    v_pk_fma_f32 v[60:61], v[60:61], v[56:57], v[58:59] op_sel_hi:[1,0,0] neg_lo:[0,0,1] neg_hi:[0,0,1]
    v_pk_fma_f32 v[62:63], v[62:63], v[56:57], v[58:59] op_sel_hi:[1,0,0] neg_lo:[0,0,1] neg_hi:[0,0,1]
    v_pk_fma_f32 v[8:9], v[8:9], v[56:57], v[58:59] op_sel_hi:[1,0,0] neg_lo:[0,0,1] neg_hi:[0,0,1]
    v_pk_fma_f32 v[10:11], v[10:11], v[56:57], v[58:59] op_sel_hi:[1,0,0] neg_lo:[0,0,1] neg_hi:[0,0,1]
    v_pk_fma_f32 v[60:61], v[60:61], v[112:113], v[120:121]
    v_pk_fma_f32 v[62:63], v[62:63], v[114:115], v[122:123]
    v_pk_fma_f32 v[8:9], v[8:9], v[116:117], v[124:125]
    v_pk_fma_f32 v[10:11], v[10:11], v[118:119], v[126:127]
    v_cvt_pk_bf16_f32 v44, v60, v61
    v_cvt_pk_bf16_f32 v45, v62, v63
    v_cvt_pk_bf16_f32 v46, v8, v9
    v_cvt_pk_bf16_f32 v47, v10, v11
    buffer_load_dwordx4 v[220:223], v4, s[12:15], s88 offen offset:3072 sc1
    ds_write_b128 v29, v[44:47] offset:6144
    v_mfma_f32_16x16x32_bf16 v[48:51], v[16:19], v[40:43], v[48:51]
    v_mfma_f32_16x16x32_bf16 v[52:55], v[40:43], v[40:43], v[52:55]
    v_mfma_f32_16x16x32_bf16 v[48:51], v[16:19], v[44:47], v[48:51]
    v_mfma_f32_16x16x32_bf16 v[52:55], v[44:47], v[44:47], v[52:55]
    v_add_u32 v27, 1024, v27
    s_nop 6
    v_cndmask_b32 v61, v52, v53, s[90:91]
    v_mov_b32 v60, v48
    v_cndmask_b32 v61, v61, v54, s[92:93]
    v_cndmask_b32 v61, v61, v55, s[94:95]
    s_mov_b64 s[98:99], exec
    s_mov_b64 exec, s[96:97]
    ds_write_b64 v27, v[60:61]
    s_mov_b64 exec, s[98:99]
    s_waitcnt lgkmcnt(0)
    s_barrier
    ds_read_b128 v[64:67], v30 offset:0
    ds_read_b128 v[68:71], v30 offset:1024
    ds_read_b128 v[72:75], v30 offset:2048
    ds_read_b128 v[76:79], v30 offset:3072
    ds_read_b128 v[80:83], v30 offset:4096
    ds_read_b128 v[84:87], v30 offset:5120
    ds_read_b128 v[88:91], v30 offset:6144
    ds_read_b128 v[92:95], v30 offset:7168
    ds_read_b128 v[96:99], v30 offset:8192
    ds_read_b128 v[100:103], v30 offset:9216
    ds_read_b128 v[104:107], v30 offset:10240
    ds_read_b128 v[108:111], v30 offset:11264
    v_lshlrev_b32 v14, 3, v2
    v_add_u32 v14, 128000, v14
    ds_read_b64 v[40:41], v14 offset:0
    ds_read_b64 v[42:43], v14 offset:256
    ds_read_b64 v[44:45], v14 offset:512
    ds_read_b64 v[46:47], v14 offset:768
    ds_read_b64 v[48:49], v14 offset:128
    ds_read_b64 v[50:51], v14 offset:384
    ds_read_b64 v[52:53], v14 offset:640
    ds_read_b64 v[54:55], v14 offset:896
    s_waitcnt lgkmcnt(15)
    v_mfma_f32_16x16x32_bf16 v[32:35], v[128:131], v[64:67], 0
    v_mfma_f32_16x16x32_bf16 v[36:39], v[128:131], v[68:71], 0
    s_add_u32 s88, s88, 4096
    buffer_load_dwordx4 v[224:227], v4, s[12:15], s88 offen sc1
    ds_read_b128 v[112:115], v30 offset:12288
    ds_read_b128 v[116:119], v30 offset:13312
    s_waitcnt lgkmcnt(10)
    v_mfma_f32_16x16x32_bf16 v[32:35], v[132:135], v[72:75], v[32:35]
    v_mfma_f32_16x16x32_bf16 v[36:39], v[132:135], v[76:79], v[36:39]
    ds_read_b128 v[120:123], v30 offset:14336
    ds_read_b128 v[124:127], v30 offset:15360
    s_waitcnt lgkmcnt(10)
    v_mfma_f32_16x16x32_bf16 v[32:35], v[136:139], v[80:83], v[32:35]
    v_mfma_f32_16x16x32_bf16 v[36:39], v[136:139], v[84:87], v[36:39]
    buffer_load_dwordx4 v[228:231], v4, s[12:15], s88 offen offset:1024 sc1
    ds_read_b128 v[64:67], v30 offset:16384
    ds_read_b128 v[68:71], v30 offset:17408
    s_waitcnt lgkmcnt(10)
    v_mfma_f32_16x16x32_bf16 v[32:35], v[140:143], v[88:91], v[32:35]
    v_mfma_f32_16x16x32_bf16 v[36:39], v[140:143], v[92:95], v[36:39]
    ds_read_b128 v[72:75], v30 offset:18432
    ds_read_b128 v[76:79], v30 offset:19456
    v_pk_add_f32 v[40:41], v[40:41], v[42:43]
    v_pk_add_f32 v[44:45], v[44:45], v[46:47]
    v_pk_add_f32 v[40:41], v[40:41], v[44:45]
    v_mul_f32 v42, 0x3b000000, v40
    v_mul_f32 v44, 0x3b000000, v41
    v_fma_f32 v44, -v42, v42, v44
    v_max_f32 v44, 0, v44
    v_add_f32 v44, 0x3727c5ac, v44
    v_rsq_f32 v44, v44
    s_waitcnt lgkmcnt(10)
    v_mfma_f32_16x16x32_bf16 v[32:35], v[144:147], v[96:99], v[32:35]
    v_mfma_f32_16x16x32_bf16 v[36:39], v[144:147], v[100:103], v[36:39]
    buffer_load_dwordx4 v[232:235], v4, s[12:15], s88 offen offset:2048 sc1
    ds_read_b128 v[80:83], v30 offset:20480
    ds_read_b128 v[84:87], v30 offset:21504
    s_waitcnt lgkmcnt(10)
    v_mfma_f32_16x16x32_bf16 v[32:35], v[148:151], v[104:107], v[32:35]
    v_mfma_f32_16x16x32_bf16 v[36:39], v[148:151], v[108:111], v[36:39]
    ds_read_b128 v[88:91], v30 offset:22528
    ds_read_b128 v[92:95], v30 offset:23552
    v_pk_add_f32 v[48:49], v[48:49], v[50:51]
    v_pk_add_f32 v[52:53], v[52:53], v[54:55]
    v_pk_add_f32 v[48:49], v[48:49], v[52:53]
    v_mul_f32 v50, 0x3b000000, v48
    v_mul_f32 v52, 0x3b000000, v49
    v_fma_f32 v52, -v50, v50, v52
    v_max_f32 v52, 0, v52
    v_add_f32 v52, 0x3727c5ac, v52
    v_rsq_f32 v52, v52
    s_waitcnt lgkmcnt(10)
    v_mfma_f32_16x16x32_bf16 v[32:35], v[152:155], v[112:115], v[32:35]
    v_mfma_f32_16x16x32_bf16 v[36:39], v[152:155], v[116:119], v[36:39]
    buffer_load_dwordx4 v[236:239], v4, s[12:15], s88 offen offset:3072 sc1
    ds_read_b128 v[96:99], v30 offset:24576
    ds_read_b128 v[100:103], v30 offset:25600
    s_waitcnt lgkmcnt(10)
    v_mfma_f32_16x16x32_bf16 v[32:35], v[156:159], v[120:123], v[32:35]
    v_mfma_f32_16x16x32_bf16 v[36:39], v[156:159], v[124:127], v[36:39]
    ds_read_b128 v[104:107], v30 offset:26624
    ds_read_b128 v[108:111], v30 offset:27648
    v_mov_b32 v56, 0xc0135761
    v_mov_b32 v58, 0xbdd2d3e8
    v_mov_b32 v60, 0x3f800000
    s_waitcnt lgkmcnt(10)
    v_mfma_f32_16x16x32_bf16 v[32:35], v[160:163], v[64:67], v[32:35]
    v_mfma_f32_16x16x32_bf16 v[36:39], v[160:163], v[68:71], v[36:39]
    s_add_u32 s88, s88, 4096
    buffer_load_dwordx4 v[240:243], v4, s[12:15], s88 offen sc1
    ds_read_b128 v[112:115], v30 offset:28672
    ds_read_b128 v[116:119], v30 offset:29696
    s_waitcnt lgkmcnt(10)
    v_mfma_f32_16x16x32_bf16 v[32:35], v[164:167], v[72:75], v[32:35]
    v_mfma_f32_16x16x32_bf16 v[36:39], v[164:167], v[76:79], v[36:39]
    ds_read_b128 v[120:123], v30 offset:30720
    ds_read_b128 v[124:127], v30 offset:31744
    s_waitcnt lgkmcnt(10)
    v_mfma_f32_16x16x32_bf16 v[32:35], v[168:171], v[80:83], v[32:35]
    v_mfma_f32_16x16x32_bf16 v[36:39], v[168:171], v[84:87], v[36:39]
    buffer_load_dwordx4 v[244:247], v4, s[12:15], s88 offen offset:1024 sc1
    s_waitcnt lgkmcnt(8)
    v_mfma_f32_16x16x32_bf16 v[32:35], v[172:175], v[88:91], v[32:35]
    v_mfma_f32_16x16x32_bf16 v[36:39], v[172:175], v[92:95], v[36:39]
    s_waitcnt lgkmcnt(6)
    v_mfma_f32_16x16x32_bf16 v[32:35], v[176:179], v[96:99], v[32:35]
    v_mfma_f32_16x16x32_bf16 v[36:39], v[176:179], v[100:103], v[36:39]
    buffer_load_dwordx4 v[248:251], v4, s[12:15], s88 offen offset:2048 sc1
    s_waitcnt lgkmcnt(4)
    v_mfma_f32_16x16x32_bf16 v[32:35], v[180:183], v[104:107], v[32:35]
    v_mfma_f32_16x16x32_bf16 v[36:39], v[180:183], v[108:111], v[36:39]
    s_waitcnt lgkmcnt(2)
    v_mfma_f32_16x16x32_bf16 v[32:35], v[184:187], v[112:115], v[32:35]
    v_mfma_f32_16x16x32_bf16 v[36:39], v[184:187], v[116:119], v[36:39]
    buffer_load_dwordx4 v[252:255], v4, s[12:15], s88 offen offset:3072 sc1
    s_waitcnt lgkmcnt(0)
    v_mfma_f32_16x16x32_bf16 v[32:35], v[188:191], v[120:123], v[32:35]
    v_mfma_f32_16x16x32_bf16 v[36:39], v[188:191], v[124:127], v[36:39]
    s_nop 6
    v_pk_fma_f32 v[32:33], v[20:21], v[42:43], v[32:33] op_sel_hi:[1,0,1] neg_lo:[0,1,0] neg_hi:[0,1,0]
    v_pk_fma_f32 v[34:35], v[22:23], v[42:43], v[34:35] op_sel_hi:[1,0,1] neg_lo:[0,1,0] neg_hi:[0,1,0]
    v_pk_fma_f32 v[36:37], v[20:21], v[50:51], v[36:37] op_sel_hi:[1,0,1] neg_lo:[0,1,0] neg_hi:[0,1,0]
    v_pk_fma_f32 v[38:39], v[22:23], v[50:51], v[38:39] op_sel_hi:[1,0,1] neg_lo:[0,1,0] neg_hi:[0,1,0]
    v_pk_mul_f32 v[32:33], v[32:33], v[44:45] op_sel_hi:[1,0]
    v_pk_mul_f32 v[34:35], v[34:35], v[44:45] op_sel_hi:[1,0]
    v_pk_mul_f32 v[36:37], v[36:37], v[52:53] op_sel_hi:[1,0]
    v_pk_mul_f32 v[38:39], v[38:39], v[52:53] op_sel_hi:[1,0]
    v_pk_mul_f32 v[64:65], v[32:33], v[32:33]
    v_pk_mul_f32 v[66:67], v[34:35], v[34:35]
    v_pk_mul_f32 v[68:69], v[36:37], v[36:37]
    v_pk_mul_f32 v[70:71], v[38:39], v[38:39]
    v_pk_fma_f32 v[64:65], v[64:65], v[58:59], v[56:57] op_sel_hi:[1,0,0]
    v_pk_fma_f32 v[66:67], v[66:67], v[58:59], v[56:57] op_sel_hi:[1,0,0]
    v_pk_fma_f32 v[68:69], v[68:69], v[58:59], v[56:57] op_sel_hi:[1,0,0]
    v_pk_fma_f32 v[70:71], v[70:71], v[58:59], v[56:57] op_sel_hi:[1,0,0]
    v_pk_mul_f32 v[64:65], v[64:65], v[32:33]
    v_pk_mul_f32 v[66:67], v[66:67], v[34:35]
    v_pk_mul_f32 v[68:69], v[68:69], v[36:37]
    v_pk_mul_f32 v[70:71], v[70:71], v[38:39]
    v_exp_f32 v64, v64
    v_exp_f32 v66, v66
    v_exp_f32 v68, v68
    v_exp_f32 v70, v70
    v_exp_f32 v65, v65
    v_exp_f32 v67, v67
    v_exp_f32 v69, v69
    v_exp_f32 v71, v71
    v_pk_add_f32 v[64:65], v[64:65], v[60:61] op_sel_hi:[1,0]
    v_pk_add_f32 v[66:67], v[66:67], v[60:61] op_sel_hi:[1,0]
    v_pk_add_f32 v[68:69], v[68:69], v[60:61] op_sel_hi:[1,0]
    v_pk_add_f32 v[70:71], v[70:71], v[60:61] op_sel_hi:[1,0]
    v_rcp_f32 v64, v64
    v_rcp_f32 v66, v66
    v_rcp_f32 v68, v68
    v_rcp_f32 v70, v70
    v_rcp_f32 v65, v65
    v_rcp_f32 v67, v67
    v_rcp_f32 v69, v69
    v_rcp_f32 v71, v71
    v_pk_mul_f32 v[32:33], v[32:33], v[64:65]
    v_pk_mul_f32 v[34:35], v[34:35], v[66:67]
    v_pk_mul_f32 v[36:37], v[36:37], v[68:69]
    v_pk_mul_f32 v[38:39], v[38:39], v[70:71]
    v_cvt_pk_bf16_f32 v40, v32, v33
    v_cvt_pk_bf16_f32 v42, v36, v37
    v_cvt_pk_bf16_f32 v41, v34, v35
    v_cvt_pk_bf16_f32 v43, v38, v39
    v_permlane16_swap_b32 v40, v42
    s_nop 0
    v_permlane16_swap_b32 v41, v43
    buffer_store_dwordx4 v[40:43], v12, s[12:15], 0 offen sc1
    v_cndmask_b32 v48, v40, v31, s[70:71]
    v_cndmask_b32 v49, v41, v31, s[70:71]
    v_cndmask_b32 v50, v42, v31, s[70:71]
    v_cndmask_b32 v51, v43, v31, s[70:71]
    s_mov_b64 s[98:99], exec
    s_mov_b32 exec_lo, 0xc0000003
    s_mov_b32 exec_hi, 0xc0000003
    buffer_store_dwordx4 v[48:51], v13, s[12:15], 0 offen sc1
    s_mov_b64 exec, s[98:99]
    s_mul_i32 s79, s78, 11
    s_cmp_eq_u32 s78, 7
    s_cselect_b32 s80, 1, 0
    s_sub_u32 s79, s79, s80
    s_add_u32 s79, s79, s5
    s_cmp_ge_u32 s78, 6
    s_cselect_b32 s80, 2, 3
    s_cmp_lt_u32 s5, s80
    s_cselect_b32 s89, 2, 1
    s_movk_i32 s70, 21504
    s_cmp_ge_u32 s5, 4
    s_cselect_b32 s70, 20480, s70
    s_cselect_b32 s73, 43008, -1
    s_and_b32 s81, s5, 3
    s_lshl_b32 s71, s78, 2
    s_add_u32 s71, s71, s81
    s_mul_i32 s71, s71, 43
    s_lshr_b32 s81, s5, 2
    s_mul_i32 s81, s81, 22
    s_add_u32 s71, s71, s81
    s_lshl_b32 s71, s71, 10
    s_add_u32 s71, s71, 15826944
    s_waitcnt vmcnt(0)
    s_barrier
    s_lshl_b32 s87, s100, 2
    s_add_u32 s87, s87, s101
    s_lshl_b32 s80, s87, 6
    s_add_u32 s80, s80, 294912
    v_mov_b32 v14, s4
    v_mov_b32 v15, 0
    s_cmp_eq_u32 s5, 0
    s_cselect_b64 exec, 1, 0
    buffer_store_dword v14, v15, s[12:15], s80 offen sc1
    s_mov_b64 exec, -1
    s_mov_b32 s80, s79
    s_mul_i32 s80, s80, 16384
    s_add_u32 s80, s80, 14417920
    buffer_load_dwordx4 v[128:131], v4, s[12:15], s80 offen sc1
    buffer_load_dwordx4 v[132:135], v4, s[12:15], s80 offen offset:1024 sc1
    buffer_load_dwordx4 v[136:139], v4, s[12:15], s80 offen offset:2048 sc1
    buffer_load_dwordx4 v[140:143], v4, s[12:15], s80 offen offset:3072 sc1
    s_add_u32 s80, s80, 4096
    buffer_load_dwordx4 v[144:147], v4, s[12:15], s80 offen sc1
    buffer_load_dwordx4 v[148:151], v4, s[12:15], s80 offen offset:1024 sc1
    buffer_load_dwordx4 v[152:155], v4, s[12:15], s80 offen offset:2048 sc1
    buffer_load_dwordx4 v[156:159], v4, s[12:15], s80 offen offset:3072 sc1
    s_cmp_lg_u32 s5, 7
    s_cbranch_scc1 L_pollskip_15
    v_min_u32 v116, 11, v1
    s_lshl_b32 s80, s100, 2
    s_sub_u32 s81, s80, 4
    v_add_u32 v116, s81, v116
    v_cmp_gt_u32 vcc, 256, v116
    v_mov_b32 v117, s80
    s_nop 0
    v_cndmask_b32 v116, v117, v116, vcc
    v_lshlrev_b32 v116, 6, v116
    s_mov_b32 s84, 0
L_poll_16:
    s_mov_b32 s81, 294912
    buffer_load_dword v118, v116, s[12:15], s81 offen sc1
    s_waitcnt vmcnt(0)
    v_cmp_ne_u32 vcc, s4, v118
    s_nop 0
    s_cbranch_vccz L_pollok_17
    s_add_u32 s84, s84, 1
    s_cmp_lt_u32 s84, 20000
    s_cbranch_scc1 L_poll_16
L_pollok_17:
L_pollskip_15:
    s_barrier
    s_mul_i32 s80, s100, 49152
    s_lshl_b32 s81, s5, 10
    s_add_u32 s80, s80, s81
    s_add_u32 s80, s80, 2490368
    s_add_u32 s83, s81, 65536
    s_mov_b32 m0, s83
    s_nop 0
    buffer_load_dwordx4 v4, s[12:15], s80 offen sc1 lds
    s_add_u32 s80, s80, 8192
    s_add_u32 s83, s81, 73728
    s_mov_b32 m0, s83
    s_nop 0
    buffer_load_dwordx4 v4, s[12:15], s80 offen sc1 lds
    s_add_u32 s80, s80, 8192
    s_add_u32 s83, s81, 81920
    s_mov_b32 m0, s83
    s_nop 0
    buffer_load_dwordx4 v4, s[12:15], s80 offen sc1 lds
    s_add_u32 s80, s80, 8192
    s_add_u32 s83, s81, 90112
    s_mov_b32 m0, s83
    s_nop 0
    buffer_load_dwordx4 v4, s[12:15], s80 offen sc1 lds
    s_add_u32 s80, s80, 8192
    s_add_u32 s83, s81, 98304
    s_mov_b32 m0, s83
    s_nop 0
    buffer_load_dwordx4 v4, s[12:15], s80 offen sc1 lds
    s_add_u32 s80, s80, 8192
    s_add_u32 s83, s81, 106496
    s_mov_b32 m0, s83
    s_nop 0
    buffer_load_dwordx4 v4, s[12:15], s80 offen sc1 lds
    v_mul_u32_u24 v24, 768, v3
    v_lshl_add_u32 v24, v2, 4, v24
    v_add_u32 v24, 65632, v24
    s_lshl_b32 s80, s101, 2
    s_lshr_b32 s81, s5, 1
    s_add_u32 s80, s80, s81
    s_lshl_b32 s80, s80, 11
    s_and_b32 s81, s5, 1
    s_lshl_b32 s81, s81, 9
    s_add_u32 s80, s80, s81
    s_add_u32 s80, s80, 32768
    v_lshrrev_b32 v25, 1, v3
    v_lshlrev_b32 v25, 8, v25
    v_lshl_add_u32 v25, v2, 4, v25
    v_and_b32 v14, 1, v3
    v_lshl_add_u32 v25, v14, 3, v25
    v_add_u32 v25, s80, v25
    ds_read_b64 v[40:41], v25
    ds_read_b64 v[42:43], v25 offset:1024
    s_waitcnt vmcnt(3)
    s_barrier
    s_mov_b32 s88, s79
    s_mul_i32 s88, s88, 16384
    s_add_u32 s88, s88, 14426112
    ds_read_b128 v[64:67], v24 offset:16
    ds_read_b128 v[68:71], v24 offset:272
    ds_read_b128 v[72:75], v24 offset:3088
    ds_read_b128 v[76:79], v24 offset:3344
    ds_read_b128 v[80:83], v24 offset:6160
    ds_read_b128 v[84:87], v24 offset:6416
    ds_read_b128 v[88:91], v24 offset:9232
    ds_read_b128 v[92:95], v24 offset:9488
    ds_read_b128 v[96:99], v24 offset:12336
    ds_read_b128 v[100:103], v24 offset:12592
    ds_read_b128 v[104:107], v24 offset:15408
    ds_read_b128 v[108:111], v24 offset:15664
    s_waitcnt lgkmcnt(10)
    v_mfma_f32_16x16x32_bf16 v[32:35], v[192:195], v[64:67], 0
    v_mfma_f32_16x16x32_bf16 v[36:39], v[192:195], v[68:71], 0
    buffer_load_dwordx4 v[160:163], v4, s[12:15], s88 offen sc1
    ds_read_b128 v[112:115], v24 offset:18480
    ds_read_b128 v[116:119], v24 offset:18736
    s_waitcnt lgkmcnt(10)
    v_mfma_f32_16x16x32_bf16 v[32:35], v[196:199], v[72:75], v[32:35]
    v_mfma_f32_16x16x32_bf16 v[36:39], v[196:199], v[76:79], v[36:39]
    ds_read_b128 v[120:123], v24 offset:21552
    ds_read_b128 v[124:127], v24 offset:21808
    s_waitcnt vmcnt(1)
    s_barrier
    s_waitcnt lgkmcnt(10)
    v_mfma_f32_16x16x32_bf16 v[32:35], v[200:203], v[80:83], v[32:35]
    v_mfma_f32_16x16x32_bf16 v[36:39], v[200:203], v[84:87], v[36:39]
    buffer_load_dwordx4 v[164:167], v4, s[12:15], s88 offen offset:1024 sc1
    ds_read_b128 v[64:67], v24 offset:24576
    ds_read_b128 v[68:71], v24 offset:24832
    s_waitcnt lgkmcnt(10)
    v_mfma_f32_16x16x32_bf16 v[32:35], v[204:207], v[88:91], v[32:35]
    v_mfma_f32_16x16x32_bf16 v[36:39], v[204:207], v[92:95], v[36:39]
    ds_read_b128 v[72:75], v24 offset:27648
    ds_read_b128 v[76:79], v24 offset:27904
    s_waitcnt lgkmcnt(10)
    v_mfma_f32_16x16x32_bf16 v[32:35], v[208:211], v[96:99], v[32:35]
    v_mfma_f32_16x16x32_bf16 v[36:39], v[208:211], v[100:103], v[36:39]
    buffer_load_dwordx4 v[168:171], v4, s[12:15], s88 offen offset:2048 sc1
    ds_read_b128 v[80:83], v24 offset:30720
    ds_read_b128 v[84:87], v24 offset:30976
    v_lshlrev_b32 v48, 16, v40
    v_and_b32 v49, 0xffff0000, v40
    v_lshlrev_b32 v50, 16, v41
    v_and_b32 v51, 0xffff0000, v41
    s_waitcnt lgkmcnt(10)
    v_mfma_f32_16x16x32_bf16 v[32:35], v[212:215], v[104:107], v[32:35]
    v_mfma_f32_16x16x32_bf16 v[36:39], v[212:215], v[108:111], v[36:39]
    ds_read_b128 v[88:91], v24 offset:33792
    ds_read_b128 v[92:95], v24 offset:34048
    s_waitcnt lgkmcnt(10)
    v_mfma_f32_16x16x32_bf16 v[32:35], v[216:219], v[112:115], v[32:35]
    v_mfma_f32_16x16x32_bf16 v[36:39], v[216:219], v[116:119], v[36:39]
    buffer_load_dwordx4 v[172:175], v4, s[12:15], s88 offen offset:3072 sc1
    ds_read_b128 v[96:99], v24 offset:36928
    ds_read_b128 v[100:103], v24 offset:37184
    v_lshlrev_b32 v52, 16, v42
    v_and_b32 v53, 0xffff0000, v42
    v_lshlrev_b32 v54, 16, v43
    v_and_b32 v55, 0xffff0000, v43
    s_waitcnt lgkmcnt(10)
    v_mfma_f32_16x16x32_bf16 v[32:35], v[220:223], v[120:123], v[32:35]
    v_mfma_f32_16x16x32_bf16 v[36:39], v[220:223], v[124:127], v[36:39]
    ds_read_b128 v[104:107], v24 offset:40000
    ds_read_b128 v[108:111], v24 offset:40256
    s_waitcnt lgkmcnt(10)
    v_mfma_f32_16x16x32_bf16 v[32:35], v[224:227], v[64:67], v[32:35]
    v_mfma_f32_16x16x32_bf16 v[36:39], v[224:227], v[68:71], v[36:39]
    s_add_u32 s88, s88, 4096
    buffer_load_dwordx4 v[176:179], v4, s[12:15], s88 offen sc1
    ds_read_b128 v[112:115], v24 offset:43072
    ds_read_b128 v[116:119], v24 offset:43328
    s_waitcnt lgkmcnt(10)
    v_mfma_f32_16x16x32_bf16 v[32:35], v[228:231], v[72:75], v[32:35]
    v_mfma_f32_16x16x32_bf16 v[36:39], v[228:231], v[76:79], v[36:39]
    ds_read_b128 v[120:123], v24 offset:46144
    ds_read_b128 v[124:127], v24 offset:46400
    s_waitcnt lgkmcnt(10)
    v_mfma_f32_16x16x32_bf16 v[32:35], v[232:235], v[80:83], v[32:35]
    v_mfma_f32_16x16x32_bf16 v[36:39], v[232:235], v[84:87], v[36:39]
    buffer_load_dwordx4 v[180:183], v4, s[12:15], s88 offen offset:1024 sc1
    s_waitcnt lgkmcnt(8)
    v_mfma_f32_16x16x32_bf16 v[32:35], v[236:239], v[88:91], v[32:35]
    v_mfma_f32_16x16x32_bf16 v[36:39], v[236:239], v[92:95], v[36:39]
    s_waitcnt lgkmcnt(6)
    v_mfma_f32_16x16x32_bf16 v[32:35], v[240:243], v[96:99], v[32:35]
    v_mfma_f32_16x16x32_bf16 v[36:39], v[240:243], v[100:103], v[36:39]
    buffer_load_dwordx4 v[184:187], v4, s[12:15], s88 offen offset:2048 sc1
    s_waitcnt lgkmcnt(4)
    v_mfma_f32_16x16x32_bf16 v[32:35], v[244:247], v[104:107], v[32:35]
    v_mfma_f32_16x16x32_bf16 v[36:39], v[244:247], v[108:111], v[36:39]
    s_waitcnt lgkmcnt(2)
    v_mfma_f32_16x16x32_bf16 v[32:35], v[248:251], v[112:115], v[32:35]
    v_mfma_f32_16x16x32_bf16 v[36:39], v[248:251], v[116:119], v[36:39]
    buffer_load_dwordx4 v[188:191], v4, s[12:15], s88 offen offset:3072 sc1
    s_waitcnt lgkmcnt(0)
    v_mfma_f32_16x16x32_bf16 v[32:35], v[252:255], v[120:123], v[32:35]
    v_mfma_f32_16x16x32_bf16 v[36:39], v[252:255], v[124:127], v[36:39]
    s_nop 6
    v_pk_add_f32 v[32:33], v[32:33], v[48:49]
    v_pk_add_f32 v[34:35], v[34:35], v[50:51]
    v_pk_add_f32 v[36:37], v[36:37], v[52:53]
    v_pk_add_f32 v[38:39], v[38:39], v[54:55]
    v_cvt_pk_bf16_f32 v40, v32, v33
    v_cvt_pk_bf16_f32 v42, v36, v37
    v_cvt_pk_bf16_f32 v41, v34, v35
    v_cvt_pk_bf16_f32 v43, v38, v39
    v_permlane16_swap_b32 v40, v42
    s_nop 0
    v_permlane16_swap_b32 v41, v43
    s_lshl_b32 s80, s100, 15
    s_lshl_b32 s81, s101, 3
    s_add_u32 s81, s81, s5
    s_lshl_b32 s81, s81, 10
    s_add_u32 s80, s80, s81
    s_add_u32 s80, s80, 5636096
    buffer_store_dwordx4 v[40:43], v4, s[12:15], s80 offen sc1
    s_waitcnt vmcnt(0)
    s_barrier
    s_lshl_b32 s87, s77, 3
    s_add_u32 s87, s87, s78
    s_lshl_b32 s80, s87, 6
    s_add_u32 s80, s80, 311296
    v_mov_b32 v14, s4
    v_mov_b32 v15, 0
    s_cmp_eq_u32 s5, 0
    s_cselect_b64 exec, 1, 0
    buffer_store_dword v14, v15, s[12:15], s80 offen sc1
    s_mov_b64 exec, -1
    s_cmp_eq_u32 s89, 1
    s_cbranch_scc1 L_p4one_18
    s_add_u32 s87, s79, 8
    s_mov_b32 s80, s87
    s_mul_i32 s80, s80, 16384
    s_add_u32 s80, s80, 14417920
    buffer_load_dwordx4 v[192:195], v4, s[12:15], s80 offen sc1
    buffer_load_dwordx4 v[196:199], v4, s[12:15], s80 offen offset:1024 sc1
    buffer_load_dwordx4 v[200:203], v4, s[12:15], s80 offen offset:2048 sc1
    buffer_load_dwordx4 v[204:207], v4, s[12:15], s80 offen offset:3072 sc1
    s_add_u32 s80, s80, 4096
    buffer_load_dwordx4 v[208:211], v4, s[12:15], s80 offen sc1
    buffer_load_dwordx4 v[212:215], v4, s[12:15], s80 offen offset:1024 sc1
    buffer_load_dwordx4 v[216:219], v4, s[12:15], s80 offen offset:2048 sc1
    buffer_load_dwordx4 v[220:223], v4, s[12:15], s80 offen offset:3072 sc1
    s_add_u32 s80, s80, 4096
    buffer_load_dwordx4 v[224:227], v4, s[12:15], s80 offen sc1
    buffer_load_dwordx4 v[228:231], v4, s[12:15], s80 offen offset:1024 sc1
    buffer_load_dwordx4 v[232:235], v4, s[12:15], s80 offen offset:2048 sc1
    buffer_load_dwordx4 v[236:239], v4, s[12:15], s80 offen offset:3072 sc1
    s_add_u32 s80, s80, 4096
    buffer_load_dwordx4 v[240:243], v4, s[12:15], s80 offen sc1
    buffer_load_dwordx4 v[244:247], v4, s[12:15], s80 offen offset:1024 sc1
    buffer_load_dwordx4 v[248:251], v4, s[12:15], s80 offen offset:2048 sc1
    buffer_load_dwordx4 v[252:255], v4, s[12:15], s80 offen offset:3072 sc1
L_p4one_18:
    v_mov_b32 v16, 0x3f803f80
    v_mov_b32 v17, 0x3f803f80
    v_mov_b32 v18, 0x3f803f80
    v_mov_b32 v19, 0x3f803f80
    s_and_b32 s85, s5, 3
    s_lshr_b32 s86, s5, 2
    v_lshrrev_b32 v14, 2, v2
    v_lshl_add_u32 v14, v3, 2, v14
    v_lshlrev_b32 v14, 6, v14
    v_and_b32 v15, 3, v2
    v_lshl_add_u32 v14, v15, 3, v14
    s_lshl_b32 s80, s86, 12
    s_lshl_b32 s81, s85, 10
    s_add_u32 s80, s80, s81
    s_add_u32 s80, s80, 114688
    v_add_u32 v14, s80, v14
    ds_read_b64_tr_b16 v[6:7], v14
    ds_read_b64_tr_b16 v[8:9], v14 offset:32
    s_lshr_b32 s80, s85, 1
    s_lshl_b32 s80, s80, 15
    s_and_b32 s81, s85, 1
    s_lshl_b32 s81, s81, 8
    s_add_u32 s80, s80, s81
    s_lshl_b32 s81, s86, 14
    s_add_u32 s80, s80, s81
    v_add_u32 v20, s80, v5
    s_lshl_b32 s80, s5, 7
    s_add_u32 s80, s80, 147456
    v_lshl_add_u32 v21, v2, 3, s80
    s_lshl_b32 s80, s86, 15
    s_lshl_b32 s81, s78, 12
    s_add_u32 s80, s80, s81
    s_lshl_b32 s81, s85, 10
    s_add_u32 s80, s80, s81
    v_lshrrev_b32 v22, 1, v3
    v_lshlrev_b32 v22, 9, v22
    v_lshl_add_u32 v22, v2, 4, v22
    v_and_b32 v14, 1, v3
    v_lshl_add_u32 v22, v14, 3, v22
    v_add_u32 v22, s80, v22
    v_lshlrev_b32 v23, 3, v2
    v_add_u32 v23, 147456, v23
    s_waitcnt lgkmcnt(0)
    s_cmp_lg_u32 s5, 7
    s_cbranch_scc1 L_pollskip_20
    v_and_b32 v116, 7, v1
    s_lshl_b32 s80, s77, 3
    v_add_u32 v116, s80, v116
    v_lshlrev_b32 v116, 6, v116
    s_mov_b32 s84, 0
L_poll_21:
    s_mov_b32 s81, 311296
    buffer_load_dword v118, v116, s[12:15], s81 offen sc1
    s_waitcnt vmcnt(0)
    v_cmp_ne_u32 vcc, s4, v118
    s_nop 0
    s_cbranch_vccz L_pollok_22
    s_add_u32 s84, s84, 1
    s_cmp_lt_u32 s84, 20000
    s_cbranch_scc1 L_poll_21
L_pollok_22:
L_pollskip_20:
    s_barrier
    s_lshl_b32 s80, s77, 16
    s_lshl_b32 s81, s86, 15
    s_lshl_b32 s82, s85, 10
    s_add_u32 s81, s81, s82
    s_add_u32 s80, s80, s81
    s_add_u32 s80, s80, 5636096
    s_add_u32 s83, s81, 0
    s_mov_b32 m0, s83
    s_nop 0
    buffer_load_dwordx4 v4, s[12:15], s80 offen sc1 lds
    s_add_u32 s80, s80, 4096
    s_add_u32 s83, s81, 4096
    s_mov_b32 m0, s83
    s_nop 0
    buffer_load_dwordx4 v4, s[12:15], s80 offen sc1 lds
    s_add_u32 s80, s80, 4096
    s_add_u32 s83, s81, 8192
    s_mov_b32 m0, s83
    s_nop 0
    buffer_load_dwordx4 v4, s[12:15], s80 offen sc1 lds
    s_add_u32 s80, s80, 4096
    s_add_u32 s83, s81, 12288
    s_mov_b32 m0, s83
    s_nop 0
    buffer_load_dwordx4 v4, s[12:15], s80 offen sc1 lds
    s_add_u32 s80, s80, 4096
    s_add_u32 s83, s81, 16384
    s_mov_b32 m0, s83
    s_nop 0
    buffer_load_dwordx4 v4, s[12:15], s80 offen sc1 lds
    s_add_u32 s80, s80, 4096
    s_add_u32 s83, s81, 20480
    s_mov_b32 m0, s83
    s_nop 0
    buffer_load_dwordx4 v4, s[12:15], s80 offen sc1 lds
    s_add_u32 s80, s80, 4096
    s_add_u32 s83, s81, 24576
    s_mov_b32 m0, s83
    s_nop 0
    buffer_load_dwordx4 v4, s[12:15], s80 offen sc1 lds
    s_add_u32 s80, s80, 4096
    s_add_u32 s83, s81, 28672
    s_mov_b32 m0, s83
    s_nop 0
    buffer_load_dwordx4 v4, s[12:15], s80 offen sc1 lds
    s_waitcnt vmcnt(8)
    v_mfma_f32_16x16x32_bf16 v[24:27], v[128:131], v[16:19], 0
    v_mfma_f32_16x16x32_bf16 v[32:35], v[132:135], v[16:19], 0
    v_mfma_f32_16x16x32_bf16 v[24:27], v[136:139], v[16:19], v[24:27]
    v_mfma_f32_16x16x32_bf16 v[32:35], v[140:143], v[16:19], v[32:35]
    v_mfma_f32_16x16x32_bf16 v[24:27], v[144:147], v[16:19], v[24:27]
    v_mfma_f32_16x16x32_bf16 v[32:35], v[148:151], v[16:19], v[32:35]
    v_mfma_f32_16x16x32_bf16 v[24:27], v[152:155], v[16:19], v[24:27]
    v_mfma_f32_16x16x32_bf16 v[32:35], v[156:159], v[16:19], v[32:35]
    v_mfma_f32_16x16x32_bf16 v[24:27], v[160:163], v[16:19], v[24:27]
    v_mfma_f32_16x16x32_bf16 v[32:35], v[164:167], v[16:19], v[32:35]
    v_mfma_f32_16x16x32_bf16 v[24:27], v[168:171], v[16:19], v[24:27]
    v_mfma_f32_16x16x32_bf16 v[32:35], v[172:175], v[16:19], v[32:35]
    v_mfma_f32_16x16x32_bf16 v[24:27], v[176:179], v[16:19], v[24:27]
    v_mfma_f32_16x16x32_bf16 v[32:35], v[180:183], v[16:19], v[32:35]
    v_mfma_f32_16x16x32_bf16 v[24:27], v[184:187], v[16:19], v[24:27]
    v_mfma_f32_16x16x32_bf16 v[32:35], v[188:191], v[16:19], v[32:35]
    s_cmp_lt_u32 s89, 2
    s_cbranch_scc1 L_nob_23
    v_mfma_f32_16x16x32_bf16 v[28:31], v[192:195], v[16:19], 0
    v_mfma_f32_16x16x32_bf16 v[36:39], v[196:199], v[16:19], 0
    v_mfma_f32_16x16x32_bf16 v[28:31], v[200:203], v[16:19], v[28:31]
    v_mfma_f32_16x16x32_bf16 v[36:39], v[204:207], v[16:19], v[36:39]
    v_mfma_f32_16x16x32_bf16 v[28:31], v[208:211], v[16:19], v[28:31]
    v_mfma_f32_16x16x32_bf16 v[36:39], v[212:215], v[16:19], v[36:39]
    v_mfma_f32_16x16x32_bf16 v[28:31], v[216:219], v[16:19], v[28:31]
    v_mfma_f32_16x16x32_bf16 v[36:39], v[220:223], v[16:19], v[36:39]
    v_mfma_f32_16x16x32_bf16 v[28:31], v[224:227], v[16:19], v[28:31]
    v_mfma_f32_16x16x32_bf16 v[36:39], v[228:231], v[16:19], v[36:39]
    v_mfma_f32_16x16x32_bf16 v[28:31], v[232:235], v[16:19], v[28:31]
    v_mfma_f32_16x16x32_bf16 v[36:39], v[236:239], v[16:19], v[36:39]
    v_mfma_f32_16x16x32_bf16 v[28:31], v[240:243], v[16:19], v[28:31]
    v_mfma_f32_16x16x32_bf16 v[36:39], v[244:247], v[16:19], v[36:39]
    v_mfma_f32_16x16x32_bf16 v[28:31], v[248:251], v[16:19], v[28:31]
    v_mfma_f32_16x16x32_bf16 v[36:39], v[252:255], v[16:19], v[36:39]
    s_nop 7
    v_add_f32 v28, v28, v36
    v_add_f32 v29, v29, v37
    v_add_f32 v30, v30, v38
    v_add_f32 v31, v31, v39
L_nob_23:
    s_nop 5
    v_add_f32 v24, v24, v32
    v_add_f32 v25, v25, v33
    v_add_f32 v26, v26, v34
    v_add_f32 v27, v27, v35
    s_lshl_b32 s80, s77, 1
    s_mul_i32 s80, s80, 88064
    s_lshl_b32 s81, s79, 10
    s_add_u32 s80, s80, s81
    s_add_u32 s87, s80, 7733248
    s_waitcnt vmcnt(0)
    s_barrier
    ds_read_b128 v[64:67], v20 offset:0
    ds_read_b128 v[68:71], v20 offset:2048
    ds_read_b128 v[72:75], v20 offset:4096
    ds_read_b128 v[76:79], v20 offset:6144
    ds_read_b128 v[80:83], v20 offset:8192
    ds_read_b128 v[84:87], v20 offset:10240
    ds_read_b128 v[88:91], v20 offset:12288
    ds_read_b128 v[92:95], v20 offset:14336
    ds_read_b64 v[10:11], v22
    ds_read_b64 v[12:13], v22 offset:256
    s_waitcnt lgkmcnt(9)
    v_mfma_f32_16x16x32_bf16 v[112:115], v[16:19], v[64:67], 0
    v_mfma_f32_16x16x32_bf16 v[116:119], v[64:67], v[64:67], 0
    s_waitcnt lgkmcnt(8)
    v_mfma_f32_16x16x32_bf16 v[48:51], v[16:19], v[68:71], 0
    v_mfma_f32_16x16x32_bf16 v[52:55], v[68:71], v[68:71], 0
    s_waitcnt lgkmcnt(7)
    v_mfma_f32_16x16x32_bf16 v[112:115], v[16:19], v[72:75], v[112:115]
    v_mfma_f32_16x16x32_bf16 v[116:119], v[72:75], v[72:75], v[116:119]
    s_waitcnt lgkmcnt(6)
    v_mfma_f32_16x16x32_bf16 v[48:51], v[16:19], v[76:79], v[48:51]
    v_mfma_f32_16x16x32_bf16 v[52:55], v[76:79], v[76:79], v[52:55]
    s_waitcnt lgkmcnt(5)
    v_mfma_f32_16x16x32_bf16 v[112:115], v[16:19], v[80:83], v[112:115]
    v_mfma_f32_16x16x32_bf16 v[116:119], v[80:83], v[80:83], v[116:119]
    s_waitcnt lgkmcnt(4)
    v_mfma_f32_16x16x32_bf16 v[48:51], v[16:19], v[84:87], v[48:51]
    v_mfma_f32_16x16x32_bf16 v[52:55], v[84:87], v[84:87], v[52:55]
    s_waitcnt lgkmcnt(3)
    v_mfma_f32_16x16x32_bf16 v[112:115], v[16:19], v[88:91], v[112:115]
    v_mfma_f32_16x16x32_bf16 v[116:119], v[88:91], v[88:91], v[116:119]
    s_waitcnt lgkmcnt(2)
    v_mfma_f32_16x16x32_bf16 v[48:51], v[16:19], v[92:95], v[48:51]
    v_mfma_f32_16x16x32_bf16 v[52:55], v[92:95], v[92:95], v[52:55]
    s_nop 6
    v_add_f32 v112, v112, v48
    v_add_f32 v116, v116, v52
    v_add_f32 v117, v117, v53
    v_add_f32 v118, v118, v54
    v_add_f32 v119, v119, v55
    v_cndmask_b32 v121, v116, v117, s[90:91]
    v_mov_b32 v120, v112
    v_cndmask_b32 v121, v121, v118, s[92:93]
    v_cndmask_b32 v121, v121, v119, s[94:95]
    s_mov_b64 s[98:99], exec
    s_mov_b64 exec, s[96:97]
    ds_write_b64 v21, v[120:121]
    s_mov_b64 exec, s[98:99]
    s_waitcnt lgkmcnt(0)
    s_barrier
    s_cmp_ge_u32 s5, 4
    s_cbranch_scc0 L_prio_24
    s_nop 0
L_prio_24:
    s_cmp_eq_u32 s89, 1
    s_cbranch_scc1 L_one_25
    ds_read_b64 v[96:97], v23 offset:0
    ds_read_b64 v[98:99], v23 offset:512
    ds_read_b64 v[100:101], v23 offset:128
    ds_read_b64 v[102:103], v23 offset:640
    ds_read_b64 v[104:105], v23 offset:256
    ds_read_b64 v[106:107], v23 offset:768
    ds_read_b64 v[108:109], v23 offset:384
    ds_read_b64 v[110:111], v23 offset:896
    ds_read_b128 v[64:67], v5 offset:0
    ds_read_b128 v[68:71], v5 offset:256
    ds_read_b128 v[72:75], v5 offset:32768
    ds_read_b128 v[76:79], v5 offset:33024
    ds_read_b128 v[80:83], v5 offset:2048
    ds_read_b128 v[84:87], v5 offset:2304
    ds_read_b128 v[88:91], v5 offset:34816
    ds_read_b128 v[92:95], v5 offset:35072
    s_waitcnt lgkmcnt(8)
    v_pk_add_f32 v[96:97], v[96:97], v[98:99]
    v_mul_f32 v120, 0x3b000000, v96
    v_mul_f32 v121, 0x3b000000, v97
    v_fma_f32 v121, -v120, v120, v121
    v_max_f32 v121, 0, v121
    v_add_f32 v121, 0x3727c5ac, v121
    v_rsq_f32 v121, v121
    v_pk_add_f32 v[100:101], v[100:101], v[102:103]
    v_mul_f32 v122, 0x3b000000, v100
    v_mul_f32 v123, 0x3b000000, v101
    v_fma_f32 v123, -v122, v122, v123
    v_max_f32 v123, 0, v123
    v_add_f32 v123, 0x3727c5ac, v123
    v_rsq_f32 v123, v123
    v_pk_add_f32 v[104:105], v[104:105], v[106:107]
    v_mul_f32 v124, 0x3b000000, v104
    v_mul_f32 v125, 0x3b000000, v105
    v_fma_f32 v125, -v124, v124, v125
    v_max_f32 v125, 0, v125
    v_add_f32 v125, 0x3727c5ac, v125
    v_rsq_f32 v125, v125
    v_pk_add_f32 v[108:109], v[108:109], v[110:111]
    v_mul_f32 v126, 0x3b000000, v108
    v_mul_f32 v127, 0x3b000000, v109
    v_fma_f32 v127, -v126, v126, v127
    v_max_f32 v127, 0, v127
    v_add_f32 v127, 0x3727c5ac, v127
    v_rsq_f32 v127, v127
    s_waitcnt lgkmcnt(4)
    v_mfma_f32_16x16x32_bf16 v[32:35], v[128:131], v[64:67], 0
    v_mfma_f32_16x16x32_bf16 v[48:51], v[192:195], v[64:67], 0
    v_mfma_f32_16x16x32_bf16 v[36:39], v[128:131], v[68:71], 0
    v_mfma_f32_16x16x32_bf16 v[52:55], v[192:195], v[68:71], 0
    v_mfma_f32_16x16x32_bf16 v[40:43], v[128:131], v[72:75], 0
    v_mfma_f32_16x16x32_bf16 v[56:59], v[192:195], v[72:75], 0
    v_mfma_f32_16x16x32_bf16 v[44:47], v[128:131], v[76:79], 0
    v_mfma_f32_16x16x32_bf16 v[60:63], v[192:195], v[76:79], 0
    ds_read_b128 v[96:99], v5 offset:4096
    ds_read_b128 v[100:103], v5 offset:4352
    ds_read_b128 v[104:107], v5 offset:36864
    ds_read_b128 v[108:111], v5 offset:37120
    s_waitcnt lgkmcnt(4)
    v_mfma_f32_16x16x32_bf16 v[32:35], v[132:135], v[80:83], v[32:35]
    v_mfma_f32_16x16x32_bf16 v[48:51], v[196:199], v[80:83], v[48:51]
    v_mfma_f32_16x16x32_bf16 v[36:39], v[132:135], v[84:87], v[36:39]
    v_mfma_f32_16x16x32_bf16 v[52:55], v[196:199], v[84:87], v[52:55]
    v_mfma_f32_16x16x32_bf16 v[40:43], v[132:135], v[88:91], v[40:43]
    v_mfma_f32_16x16x32_bf16 v[56:59], v[196:199], v[88:91], v[56:59]
    v_mfma_f32_16x16x32_bf16 v[44:47], v[132:135], v[92:95], v[44:47]
    v_mfma_f32_16x16x32_bf16 v[60:63], v[196:199], v[92:95], v[60:63]
    ds_read_b128 v[64:67], v5 offset:6144
    ds_read_b128 v[68:71], v5 offset:6400
    ds_read_b128 v[72:75], v5 offset:38912
    ds_read_b128 v[76:79], v5 offset:39168
    s_waitcnt lgkmcnt(4)
    v_mfma_f32_16x16x32_bf16 v[32:35], v[136:139], v[96:99], v[32:35]
    v_mfma_f32_16x16x32_bf16 v[48:51], v[200:203], v[96:99], v[48:51]
    v_mfma_f32_16x16x32_bf16 v[36:39], v[136:139], v[100:103], v[36:39]
    v_mfma_f32_16x16x32_bf16 v[52:55], v[200:203], v[100:103], v[52:55]
    v_mfma_f32_16x16x32_bf16 v[40:43], v[136:139], v[104:107], v[40:43]
    v_mfma_f32_16x16x32_bf16 v[56:59], v[200:203], v[104:107], v[56:59]
    v_mfma_f32_16x16x32_bf16 v[44:47], v[136:139], v[108:111], v[44:47]
    v_mfma_f32_16x16x32_bf16 v[60:63], v[200:203], v[108:111], v[60:63]
    ds_read_b128 v[80:83], v5 offset:8192
    ds_read_b128 v[84:87], v5 offset:8448
    ds_read_b128 v[88:91], v5 offset:40960
    ds_read_b128 v[92:95], v5 offset:41216
    s_waitcnt lgkmcnt(4)
    v_mfma_f32_16x16x32_bf16 v[32:35], v[140:143], v[64:67], v[32:35]
    v_mfma_f32_16x16x32_bf16 v[48:51], v[204:207], v[64:67], v[48:51]
    v_mfma_f32_16x16x32_bf16 v[36:39], v[140:143], v[68:71], v[36:39]
    v_mfma_f32_16x16x32_bf16 v[52:55], v[204:207], v[68:71], v[52:55]
    v_mfma_f32_16x16x32_bf16 v[40:43], v[140:143], v[72:75], v[40:43]
    v_mfma_f32_16x16x32_bf16 v[56:59], v[204:207], v[72:75], v[56:59]
    v_mfma_f32_16x16x32_bf16 v[44:47], v[140:143], v[76:79], v[44:47]
    v_mfma_f32_16x16x32_bf16 v[60:63], v[204:207], v[76:79], v[60:63]
    ds_read_b128 v[96:99], v5 offset:10240
    ds_read_b128 v[100:103], v5 offset:10496
    ds_read_b128 v[104:107], v5 offset:43008
    ds_read_b128 v[108:111], v5 offset:43264
    s_waitcnt lgkmcnt(4)
    v_mfma_f32_16x16x32_bf16 v[32:35], v[144:147], v[80:83], v[32:35]
    v_mfma_f32_16x16x32_bf16 v[48:51], v[208:211], v[80:83], v[48:51]
    v_mfma_f32_16x16x32_bf16 v[36:39], v[144:147], v[84:87], v[36:39]
    v_mfma_f32_16x16x32_bf16 v[52:55], v[208:211], v[84:87], v[52:55]
    v_mfma_f32_16x16x32_bf16 v[40:43], v[144:147], v[88:91], v[40:43]
    v_mfma_f32_16x16x32_bf16 v[56:59], v[208:211], v[88:91], v[56:59]
    v_mfma_f32_16x16x32_bf16 v[44:47], v[144:147], v[92:95], v[44:47]
    v_mfma_f32_16x16x32_bf16 v[60:63], v[208:211], v[92:95], v[60:63]
    ds_read_b128 v[64:67], v5 offset:12288
    ds_read_b128 v[68:71], v5 offset:12544
    ds_read_b128 v[72:75], v5 offset:45056
    ds_read_b128 v[76:79], v5 offset:45312
    s_waitcnt lgkmcnt(4)
    v_mfma_f32_16x16x32_bf16 v[32:35], v[148:151], v[96:99], v[32:35]
    v_mfma_f32_16x16x32_bf16 v[48:51], v[212:215], v[96:99], v[48:51]
    v_mfma_f32_16x16x32_bf16 v[36:39], v[148:151], v[100:103], v[36:39]
    v_mfma_f32_16x16x32_bf16 v[52:55], v[212:215], v[100:103], v[52:55]
    v_mfma_f32_16x16x32_bf16 v[40:43], v[148:151], v[104:107], v[40:43]
    v_mfma_f32_16x16x32_bf16 v[56:59], v[212:215], v[104:107], v[56:59]
    v_mfma_f32_16x16x32_bf16 v[44:47], v[148:151], v[108:111], v[44:47]
    v_mfma_f32_16x16x32_bf16 v[60:63], v[212:215], v[108:111], v[60:63]
    ds_read_b128 v[80:83], v5 offset:14336
    ds_read_b128 v[84:87], v5 offset:14592
    ds_read_b128 v[88:91], v5 offset:47104
    ds_read_b128 v[92:95], v5 offset:47360
    s_waitcnt lgkmcnt(4)
    v_mfma_f32_16x16x32_bf16 v[32:35], v[152:155], v[64:67], v[32:35]
    v_mfma_f32_16x16x32_bf16 v[48:51], v[216:219], v[64:67], v[48:51]
    v_mfma_f32_16x16x32_bf16 v[36:39], v[152:155], v[68:71], v[36:39]
    v_mfma_f32_16x16x32_bf16 v[52:55], v[216:219], v[68:71], v[52:55]
    v_mfma_f32_16x16x32_bf16 v[40:43], v[152:155], v[72:75], v[40:43]
    v_mfma_f32_16x16x32_bf16 v[56:59], v[216:219], v[72:75], v[56:59]
    v_mfma_f32_16x16x32_bf16 v[44:47], v[152:155], v[76:79], v[44:47]
    v_mfma_f32_16x16x32_bf16 v[60:63], v[216:219], v[76:79], v[60:63]
    ds_read_b128 v[96:99], v5 offset:16384
    ds_read_b128 v[100:103], v5 offset:16640
    ds_read_b128 v[104:107], v5 offset:49152
    ds_read_b128 v[108:111], v5 offset:49408
    s_waitcnt lgkmcnt(4)
    v_mfma_f32_16x16x32_bf16 v[32:35], v[156:159], v[80:83], v[32:35]
    v_mfma_f32_16x16x32_bf16 v[48:51], v[220:223], v[80:83], v[48:51]
    v_mfma_f32_16x16x32_bf16 v[36:39], v[156:159], v[84:87], v[36:39]
    v_mfma_f32_16x16x32_bf16 v[52:55], v[220:223], v[84:87], v[52:55]
    v_mfma_f32_16x16x32_bf16 v[40:43], v[156:159], v[88:91], v[40:43]
    v_mfma_f32_16x16x32_bf16 v[56:59], v[220:223], v[88:91], v[56:59]
    v_mfma_f32_16x16x32_bf16 v[44:47], v[156:159], v[92:95], v[44:47]
    v_mfma_f32_16x16x32_bf16 v[60:63], v[220:223], v[92:95], v[60:63]
    ds_read_b128 v[64:67], v5 offset:18432
    ds_read_b128 v[68:71], v5 offset:18688
    ds_read_b128 v[72:75], v5 offset:51200
    ds_read_b128 v[76:79], v5 offset:51456
    s_waitcnt lgkmcnt(4)
    v_mfma_f32_16x16x32_bf16 v[32:35], v[160:163], v[96:99], v[32:35]
    v_mfma_f32_16x16x32_bf16 v[48:51], v[224:227], v[96:99], v[48:51]
    v_mfma_f32_16x16x32_bf16 v[36:39], v[160:163], v[100:103], v[36:39]
    v_mfma_f32_16x16x32_bf16 v[52:55], v[224:227], v[100:103], v[52:55]
    v_mfma_f32_16x16x32_bf16 v[40:43], v[160:163], v[104:107], v[40:43]
    v_mfma_f32_16x16x32_bf16 v[56:59], v[224:227], v[104:107], v[56:59]
    v_mfma_f32_16x16x32_bf16 v[44:47], v[160:163], v[108:111], v[44:47]
    v_mfma_f32_16x16x32_bf16 v[60:63], v[224:227], v[108:111], v[60:63]
    ds_read_b128 v[80:83], v5 offset:20480
    ds_read_b128 v[84:87], v5 offset:20736
    ds_read_b128 v[88:91], v5 offset:53248
    ds_read_b128 v[92:95], v5 offset:53504
    v_lshlrev_b32 v14, 7, v1
    s_mul_i32 s80, s7, 44032
    s_sub_u32 s81, s5, 2
    s_lshl_b32 s81, s81, 13
    s_add_u32 s80, s80, s81
    s_add_u32 s80, s80, 15826944
    s_cmp_ge_u32 s5, 2
    s_cselect_b64 exec, -1, 0
    buffer_load_dword v15, v14, s[12:15], s80 offen
    s_mov_b64 exec, -1
    s_waitcnt lgkmcnt(4)
    v_mfma_f32_16x16x32_bf16 v[32:35], v[164:167], v[64:67], v[32:35]
    v_mfma_f32_16x16x32_bf16 v[48:51], v[228:231], v[64:67], v[48:51]
    v_mfma_f32_16x16x32_bf16 v[36:39], v[164:167], v[68:71], v[36:39]
    v_mfma_f32_16x16x32_bf16 v[52:55], v[228:231], v[68:71], v[52:55]
    v_mfma_f32_16x16x32_bf16 v[40:43], v[164:167], v[72:75], v[40:43]
    v_mfma_f32_16x16x32_bf16 v[56:59], v[228:231], v[72:75], v[56:59]
    v_mfma_f32_16x16x32_bf16 v[44:47], v[164:167], v[76:79], v[44:47]
    v_mfma_f32_16x16x32_bf16 v[60:63], v[228:231], v[76:79], v[60:63]
    ds_read_b128 v[96:99], v5 offset:22528
    ds_read_b128 v[100:103], v5 offset:22784
    ds_read_b128 v[104:107], v5 offset:55296
    ds_read_b128 v[108:111], v5 offset:55552
    s_waitcnt lgkmcnt(4)
    v_mfma_f32_16x16x32_bf16 v[32:35], v[168:171], v[80:83], v[32:35]
    v_mfma_f32_16x16x32_bf16 v[48:51], v[232:235], v[80:83], v[48:51]
    v_mfma_f32_16x16x32_bf16 v[36:39], v[168:171], v[84:87], v[36:39]
    v_mfma_f32_16x16x32_bf16 v[52:55], v[232:235], v[84:87], v[52:55]
    v_mfma_f32_16x16x32_bf16 v[40:43], v[168:171], v[88:91], v[40:43]
    v_mfma_f32_16x16x32_bf16 v[56:59], v[232:235], v[88:91], v[56:59]
    v_mfma_f32_16x16x32_bf16 v[44:47], v[168:171], v[92:95], v[44:47]
    v_mfma_f32_16x16x32_bf16 v[60:63], v[232:235], v[92:95], v[60:63]
    ds_read_b128 v[64:67], v5 offset:24576
    ds_read_b128 v[68:71], v5 offset:24832
    ds_read_b128 v[72:75], v5 offset:57344
    ds_read_b128 v[76:79], v5 offset:57600
    s_waitcnt lgkmcnt(4)
    v_mfma_f32_16x16x32_bf16 v[32:35], v[172:175], v[96:99], v[32:35]
    v_mfma_f32_16x16x32_bf16 v[48:51], v[236:239], v[96:99], v[48:51]
    v_mfma_f32_16x16x32_bf16 v[36:39], v[172:175], v[100:103], v[36:39]
    v_mfma_f32_16x16x32_bf16 v[52:55], v[236:239], v[100:103], v[52:55]
    v_mfma_f32_16x16x32_bf16 v[40:43], v[172:175], v[104:107], v[40:43]
    v_mfma_f32_16x16x32_bf16 v[56:59], v[236:239], v[104:107], v[56:59]
    v_mfma_f32_16x16x32_bf16 v[44:47], v[172:175], v[108:111], v[44:47]
    v_mfma_f32_16x16x32_bf16 v[60:63], v[236:239], v[108:111], v[60:63]
    ds_read_b128 v[80:83], v5 offset:26624
    ds_read_b128 v[84:87], v5 offset:26880
    ds_read_b128 v[88:91], v5 offset:59392
    ds_read_b128 v[92:95], v5 offset:59648
    s_waitcnt lgkmcnt(4)
    v_mfma_f32_16x16x32_bf16 v[32:35], v[176:179], v[64:67], v[32:35]
    v_mfma_f32_16x16x32_bf16 v[48:51], v[240:243], v[64:67], v[48:51]
    v_mfma_f32_16x16x32_bf16 v[36:39], v[176:179], v[68:71], v[36:39]
    v_mfma_f32_16x16x32_bf16 v[52:55], v[240:243], v[68:71], v[52:55]
    v_mfma_f32_16x16x32_bf16 v[40:43], v[176:179], v[72:75], v[40:43]
    v_mfma_f32_16x16x32_bf16 v[56:59], v[240:243], v[72:75], v[56:59]
    v_mfma_f32_16x16x32_bf16 v[44:47], v[176:179], v[76:79], v[44:47]
    v_mfma_f32_16x16x32_bf16 v[60:63], v[240:243], v[76:79], v[60:63]
    ds_read_b128 v[96:99], v5 offset:28672
    ds_read_b128 v[100:103], v5 offset:28928
    ds_read_b128 v[104:107], v5 offset:61440
    ds_read_b128 v[108:111], v5 offset:61696
    s_waitcnt lgkmcnt(4)
    v_mfma_f32_16x16x32_bf16 v[32:35], v[180:183], v[80:83], v[32:35]
    v_mfma_f32_16x16x32_bf16 v[48:51], v[244:247], v[80:83], v[48:51]
    v_mfma_f32_16x16x32_bf16 v[36:39], v[180:183], v[84:87], v[36:39]
    v_mfma_f32_16x16x32_bf16 v[52:55], v[244:247], v[84:87], v[52:55]
    v_mfma_f32_16x16x32_bf16 v[40:43], v[180:183], v[88:91], v[40:43]
    v_mfma_f32_16x16x32_bf16 v[56:59], v[244:247], v[88:91], v[56:59]
    v_mfma_f32_16x16x32_bf16 v[44:47], v[180:183], v[92:95], v[44:47]
    v_mfma_f32_16x16x32_bf16 v[60:63], v[244:247], v[92:95], v[60:63]
    ds_read_b128 v[64:67], v5 offset:30720
    ds_read_b128 v[68:71], v5 offset:30976
    ds_read_b128 v[72:75], v5 offset:63488
    ds_read_b128 v[76:79], v5 offset:63744
    s_waitcnt lgkmcnt(4)
    v_mfma_f32_16x16x32_bf16 v[32:35], v[184:187], v[96:99], v[32:35]
    v_mfma_f32_16x16x32_bf16 v[48:51], v[248:251], v[96:99], v[48:51]
    v_mfma_f32_16x16x32_bf16 v[36:39], v[184:187], v[100:103], v[36:39]
    v_mfma_f32_16x16x32_bf16 v[52:55], v[248:251], v[100:103], v[52:55]
    v_mfma_f32_16x16x32_bf16 v[40:43], v[184:187], v[104:107], v[40:43]
    v_mfma_f32_16x16x32_bf16 v[56:59], v[248:251], v[104:107], v[56:59]
    v_mfma_f32_16x16x32_bf16 v[44:47], v[184:187], v[108:111], v[44:47]
    v_mfma_f32_16x16x32_bf16 v[60:63], v[248:251], v[108:111], v[60:63]
    s_waitcnt lgkmcnt(0)
    v_mfma_f32_16x16x32_bf16 v[32:35], v[188:191], v[64:67], v[32:35]
    v_mfma_f32_16x16x32_bf16 v[48:51], v[252:255], v[64:67], v[48:51]
    v_mfma_f32_16x16x32_bf16 v[36:39], v[188:191], v[68:71], v[36:39]
    v_mfma_f32_16x16x32_bf16 v[52:55], v[252:255], v[68:71], v[52:55]
    v_mfma_f32_16x16x32_bf16 v[40:43], v[188:191], v[72:75], v[40:43]
    v_mfma_f32_16x16x32_bf16 v[56:59], v[252:255], v[72:75], v[56:59]
    v_mfma_f32_16x16x32_bf16 v[44:47], v[188:191], v[76:79], v[44:47]
    v_mfma_f32_16x16x32_bf16 v[60:63], v[252:255], v[76:79], v[60:63]
    v_mov_b32 v64, 0xc0135761
    v_mov_b32 v66, 0xbdd2d3e8
    v_mov_b32 v68, 0x3f800000
    v_pk_fma_f32 v[32:33], v[24:25], v[120:121], v[32:33] op_sel_hi:[1,0,1] neg_lo:[0,1,0] neg_hi:[0,1,0]
    v_pk_fma_f32 v[34:35], v[26:27], v[120:121], v[34:35] op_sel_hi:[1,0,1] neg_lo:[0,1,0] neg_hi:[0,1,0]
    v_pk_fma_f32 v[36:37], v[24:25], v[122:123], v[36:37] op_sel_hi:[1,0,1] neg_lo:[0,1,0] neg_hi:[0,1,0]
    v_pk_fma_f32 v[38:39], v[26:27], v[122:123], v[38:39] op_sel_hi:[1,0,1] neg_lo:[0,1,0] neg_hi:[0,1,0]
    v_pk_mul_f32 v[32:33], v[32:33], v[120:121] op_sel:[0,1] op_sel_hi:[1,1]
    v_pk_mul_f32 v[34:35], v[34:35], v[120:121] op_sel:[0,1] op_sel_hi:[1,1]
    v_pk_mul_f32 v[36:37], v[36:37], v[122:123] op_sel:[0,1] op_sel_hi:[1,1]
    v_pk_mul_f32 v[38:39], v[38:39], v[122:123] op_sel:[0,1] op_sel_hi:[1,1]
    v_pk_mul_f32 v[96:97], v[32:33], v[32:33]
    v_pk_mul_f32 v[98:99], v[34:35], v[34:35]
    v_pk_mul_f32 v[100:101], v[36:37], v[36:37]
    v_pk_mul_f32 v[102:103], v[38:39], v[38:39]
    v_pk_fma_f32 v[96:97], v[96:97], v[66:67], v[64:65] op_sel_hi:[1,0,0]
    v_pk_fma_f32 v[98:99], v[98:99], v[66:67], v[64:65] op_sel_hi:[1,0,0]
    v_pk_fma_f32 v[100:101], v[100:101], v[66:67], v[64:65] op_sel_hi:[1,0,0]
    v_pk_fma_f32 v[102:103], v[102:103], v[66:67], v[64:65] op_sel_hi:[1,0,0]
    v_pk_mul_f32 v[96:97], v[96:97], v[32:33]
    v_pk_mul_f32 v[98:99], v[98:99], v[34:35]
    v_pk_mul_f32 v[100:101], v[100:101], v[36:37]
    v_pk_mul_f32 v[102:103], v[102:103], v[38:39]
    v_exp_f32 v96, v96
    v_exp_f32 v98, v98
    v_exp_f32 v100, v100
    v_exp_f32 v102, v102
    v_exp_f32 v97, v97
    v_exp_f32 v99, v99
    v_exp_f32 v101, v101
    v_exp_f32 v103, v103
    v_pk_add_f32 v[96:97], v[96:97], v[68:69] op_sel_hi:[1,0]
    v_pk_add_f32 v[98:99], v[98:99], v[68:69] op_sel_hi:[1,0]
    v_pk_add_f32 v[100:101], v[100:101], v[68:69] op_sel_hi:[1,0]
    v_pk_add_f32 v[102:103], v[102:103], v[68:69] op_sel_hi:[1,0]
    v_rcp_f32 v96, v96
    v_rcp_f32 v98, v98
    v_rcp_f32 v100, v100
    v_rcp_f32 v102, v102
    v_rcp_f32 v97, v97
    v_rcp_f32 v99, v99
    v_rcp_f32 v101, v101
    v_rcp_f32 v103, v103
    v_pk_mul_f32 v[32:33], v[32:33], v[96:97]
    v_pk_mul_f32 v[34:35], v[34:35], v[98:99]
    v_pk_mul_f32 v[36:37], v[36:37], v[100:101]
    v_pk_mul_f32 v[38:39], v[38:39], v[102:103]
    v_cvt_pk_bf16_f32 v76, v32, v33
    v_cvt_pk_bf16_f32 v78, v36, v37
    v_cvt_pk_bf16_f32 v77, v34, v35
    v_cvt_pk_bf16_f32 v79, v38, v39
    v_permlane16_swap_b32 v76, v78
    s_nop 0
    v_permlane16_swap_b32 v77, v79
    s_add_u32 s80, s87, 0
    buffer_store_dwordx4 v[76:79], v4, s[12:15], s80 offen sc1
    v_pk_fma_f32 v[40:41], v[24:25], v[124:125], v[40:41] op_sel_hi:[1,0,1] neg_lo:[0,1,0] neg_hi:[0,1,0]
    v_pk_fma_f32 v[42:43], v[26:27], v[124:125], v[42:43] op_sel_hi:[1,0,1] neg_lo:[0,1,0] neg_hi:[0,1,0]
    v_pk_fma_f32 v[44:45], v[24:25], v[126:127], v[44:45] op_sel_hi:[1,0,1] neg_lo:[0,1,0] neg_hi:[0,1,0]
    v_pk_fma_f32 v[46:47], v[26:27], v[126:127], v[46:47] op_sel_hi:[1,0,1] neg_lo:[0,1,0] neg_hi:[0,1,0]
    v_pk_mul_f32 v[40:41], v[40:41], v[124:125] op_sel:[0,1] op_sel_hi:[1,1]
    v_pk_mul_f32 v[42:43], v[42:43], v[124:125] op_sel:[0,1] op_sel_hi:[1,1]
    v_pk_mul_f32 v[44:45], v[44:45], v[126:127] op_sel:[0,1] op_sel_hi:[1,1]
    v_pk_mul_f32 v[46:47], v[46:47], v[126:127] op_sel:[0,1] op_sel_hi:[1,1]
    v_pk_mul_f32 v[96:97], v[40:41], v[40:41]
    v_pk_mul_f32 v[98:99], v[42:43], v[42:43]
    v_pk_mul_f32 v[100:101], v[44:45], v[44:45]
    v_pk_mul_f32 v[102:103], v[46:47], v[46:47]
    v_pk_fma_f32 v[96:97], v[96:97], v[66:67], v[64:65] op_sel_hi:[1,0,0]
    v_pk_fma_f32 v[98:99], v[98:99], v[66:67], v[64:65] op_sel_hi:[1,0,0]
    v_pk_fma_f32 v[100:101], v[100:101], v[66:67], v[64:65] op_sel_hi:[1,0,0]
    v_pk_fma_f32 v[102:103], v[102:103], v[66:67], v[64:65] op_sel_hi:[1,0,0]
    v_pk_mul_f32 v[96:97], v[96:97], v[40:41]
    v_pk_mul_f32 v[98:99], v[98:99], v[42:43]
    v_pk_mul_f32 v[100:101], v[100:101], v[44:45]
    v_pk_mul_f32 v[102:103], v[102:103], v[46:47]
    v_exp_f32 v96, v96
    v_exp_f32 v98, v98
    v_exp_f32 v100, v100
    v_exp_f32 v102, v102
    v_exp_f32 v97, v97
    v_exp_f32 v99, v99
    v_exp_f32 v101, v101
    v_exp_f32 v103, v103
    v_pk_add_f32 v[96:97], v[96:97], v[68:69] op_sel_hi:[1,0]
    v_pk_add_f32 v[98:99], v[98:99], v[68:69] op_sel_hi:[1,0]
    v_pk_add_f32 v[100:101], v[100:101], v[68:69] op_sel_hi:[1,0]
    v_pk_add_f32 v[102:103], v[102:103], v[68:69] op_sel_hi:[1,0]
    v_rcp_f32 v96, v96
    v_rcp_f32 v98, v98
    v_rcp_f32 v100, v100
    v_rcp_f32 v102, v102
    v_rcp_f32 v97, v97
    v_rcp_f32 v99, v99
    v_rcp_f32 v101, v101
    v_rcp_f32 v103, v103
    v_pk_mul_f32 v[40:41], v[40:41], v[96:97]
    v_pk_mul_f32 v[42:43], v[42:43], v[98:99]
    v_pk_mul_f32 v[44:45], v[44:45], v[100:101]
    v_pk_mul_f32 v[46:47], v[46:47], v[102:103]
    v_cvt_pk_bf16_f32 v80, v40, v41
    v_cvt_pk_bf16_f32 v82, v44, v45
    v_cvt_pk_bf16_f32 v81, v42, v43
    v_cvt_pk_bf16_f32 v83, v46, v47
    v_permlane16_swap_b32 v80, v82
    s_nop 0
    v_permlane16_swap_b32 v81, v83
    s_add_u32 s80, s87, 88064
    buffer_store_dwordx4 v[80:83], v4, s[12:15], s80 offen sc1
    v_pk_fma_f32 v[48:49], v[28:29], v[120:121], v[48:49] op_sel_hi:[1,0,1] neg_lo:[0,1,0] neg_hi:[0,1,0]
    v_pk_fma_f32 v[50:51], v[30:31], v[120:121], v[50:51] op_sel_hi:[1,0,1] neg_lo:[0,1,0] neg_hi:[0,1,0]
    v_pk_fma_f32 v[52:53], v[28:29], v[122:123], v[52:53] op_sel_hi:[1,0,1] neg_lo:[0,1,0] neg_hi:[0,1,0]
    v_pk_fma_f32 v[54:55], v[30:31], v[122:123], v[54:55] op_sel_hi:[1,0,1] neg_lo:[0,1,0] neg_hi:[0,1,0]
    v_pk_mul_f32 v[48:49], v[48:49], v[120:121] op_sel:[0,1] op_sel_hi:[1,1]
    v_pk_mul_f32 v[50:51], v[50:51], v[120:121] op_sel:[0,1] op_sel_hi:[1,1]
    v_pk_mul_f32 v[52:53], v[52:53], v[122:123] op_sel:[0,1] op_sel_hi:[1,1]
    v_pk_mul_f32 v[54:55], v[54:55], v[122:123] op_sel:[0,1] op_sel_hi:[1,1]
    v_pk_mul_f32 v[96:97], v[48:49], v[48:49]
    v_pk_mul_f32 v[98:99], v[50:51], v[50:51]
    v_pk_mul_f32 v[100:101], v[52:53], v[52:53]
    v_pk_mul_f32 v[102:103], v[54:55], v[54:55]
    v_pk_fma_f32 v[96:97], v[96:97], v[66:67], v[64:65] op_sel_hi:[1,0,0]
    v_pk_fma_f32 v[98:99], v[98:99], v[66:67], v[64:65] op_sel_hi:[1,0,0]
    v_pk_fma_f32 v[100:101], v[100:101], v[66:67], v[64:65] op_sel_hi:[1,0,0]
    v_pk_fma_f32 v[102:103], v[102:103], v[66:67], v[64:65] op_sel_hi:[1,0,0]
    v_pk_mul_f32 v[96:97], v[96:97], v[48:49]
    v_pk_mul_f32 v[98:99], v[98:99], v[50:51]
    v_pk_mul_f32 v[100:101], v[100:101], v[52:53]
    v_pk_mul_f32 v[102:103], v[102:103], v[54:55]
    v_exp_f32 v96, v96
    v_exp_f32 v98, v98
    v_exp_f32 v100, v100
    v_exp_f32 v102, v102
    v_exp_f32 v97, v97
    v_exp_f32 v99, v99
    v_exp_f32 v101, v101
    v_exp_f32 v103, v103
    v_pk_add_f32 v[96:97], v[96:97], v[68:69] op_sel_hi:[1,0]
    v_pk_add_f32 v[98:99], v[98:99], v[68:69] op_sel_hi:[1,0]
    v_pk_add_f32 v[100:101], v[100:101], v[68:69] op_sel_hi:[1,0]
    v_pk_add_f32 v[102:103], v[102:103], v[68:69] op_sel_hi:[1,0]
    v_rcp_f32 v96, v96
    v_rcp_f32 v98, v98
    v_rcp_f32 v100, v100
    v_rcp_f32 v102, v102
    v_rcp_f32 v97, v97
    v_rcp_f32 v99, v99
    v_rcp_f32 v101, v101
    v_rcp_f32 v103, v103
    v_pk_mul_f32 v[48:49], v[48:49], v[96:97]
    v_pk_mul_f32 v[50:51], v[50:51], v[98:99]
    v_pk_mul_f32 v[52:53], v[52:53], v[100:101]
    v_pk_mul_f32 v[54:55], v[54:55], v[102:103]
    v_cvt_pk_bf16_f32 v84, v48, v49
    v_cvt_pk_bf16_f32 v86, v52, v53
    v_cvt_pk_bf16_f32 v85, v50, v51
    v_cvt_pk_bf16_f32 v87, v54, v55
    v_permlane16_swap_b32 v84, v86
    s_nop 0
    v_permlane16_swap_b32 v85, v87
    s_add_u32 s80, s87, 8192
    buffer_store_dwordx4 v[84:87], v4, s[12:15], s80 offen sc1
    v_pk_fma_f32 v[56:57], v[28:29], v[124:125], v[56:57] op_sel_hi:[1,0,1] neg_lo:[0,1,0] neg_hi:[0,1,0]
    v_pk_fma_f32 v[58:59], v[30:31], v[124:125], v[58:59] op_sel_hi:[1,0,1] neg_lo:[0,1,0] neg_hi:[0,1,0]
    v_pk_fma_f32 v[60:61], v[28:29], v[126:127], v[60:61] op_sel_hi:[1,0,1] neg_lo:[0,1,0] neg_hi:[0,1,0]
    v_pk_fma_f32 v[62:63], v[30:31], v[126:127], v[62:63] op_sel_hi:[1,0,1] neg_lo:[0,1,0] neg_hi:[0,1,0]
    v_pk_mul_f32 v[56:57], v[56:57], v[124:125] op_sel:[0,1] op_sel_hi:[1,1]
    v_pk_mul_f32 v[58:59], v[58:59], v[124:125] op_sel:[0,1] op_sel_hi:[1,1]
    v_pk_mul_f32 v[60:61], v[60:61], v[126:127] op_sel:[0,1] op_sel_hi:[1,1]
    v_pk_mul_f32 v[62:63], v[62:63], v[126:127] op_sel:[0,1] op_sel_hi:[1,1]
    v_pk_mul_f32 v[96:97], v[56:57], v[56:57]
    v_pk_mul_f32 v[98:99], v[58:59], v[58:59]
    v_pk_mul_f32 v[100:101], v[60:61], v[60:61]
    v_pk_mul_f32 v[102:103], v[62:63], v[62:63]
    v_pk_fma_f32 v[96:97], v[96:97], v[66:67], v[64:65] op_sel_hi:[1,0,0]
    v_pk_fma_f32 v[98:99], v[98:99], v[66:67], v[64:65] op_sel_hi:[1,0,0]
    v_pk_fma_f32 v[100:101], v[100:101], v[66:67], v[64:65] op_sel_hi:[1,0,0]
    v_pk_fma_f32 v[102:103], v[102:103], v[66:67], v[64:65] op_sel_hi:[1,0,0]
    v_pk_mul_f32 v[96:97], v[96:97], v[56:57]
    v_pk_mul_f32 v[98:99], v[98:99], v[58:59]
    v_pk_mul_f32 v[100:101], v[100:101], v[60:61]
    v_pk_mul_f32 v[102:103], v[102:103], v[62:63]
    v_exp_f32 v96, v96
    v_exp_f32 v98, v98
    v_exp_f32 v100, v100
    v_exp_f32 v102, v102
    v_exp_f32 v97, v97
    v_exp_f32 v99, v99
    v_exp_f32 v101, v101
    v_exp_f32 v103, v103
    v_pk_add_f32 v[96:97], v[96:97], v[68:69] op_sel_hi:[1,0]
    v_pk_add_f32 v[98:99], v[98:99], v[68:69] op_sel_hi:[1,0]
    v_pk_add_f32 v[100:101], v[100:101], v[68:69] op_sel_hi:[1,0]
    v_pk_add_f32 v[102:103], v[102:103], v[68:69] op_sel_hi:[1,0]
    v_rcp_f32 v96, v96
    v_rcp_f32 v98, v98
    v_rcp_f32 v100, v100
    v_rcp_f32 v102, v102
    v_rcp_f32 v97, v97
    v_rcp_f32 v99, v99
    v_rcp_f32 v101, v101
    v_rcp_f32 v103, v103
    v_pk_mul_f32 v[56:57], v[56:57], v[96:97]
    v_pk_mul_f32 v[58:59], v[58:59], v[98:99]
    v_pk_mul_f32 v[60:61], v[60:61], v[100:101]
    v_pk_mul_f32 v[62:63], v[62:63], v[102:103]
    v_cvt_pk_bf16_f32 v88, v56, v57
    v_cvt_pk_bf16_f32 v90, v60, v61
    v_cvt_pk_bf16_f32 v89, v58, v59
    v_cvt_pk_bf16_f32 v91, v62, v63
    v_permlane16_swap_b32 v88, v90
    s_nop 0
    v_permlane16_swap_b32 v89, v91
    s_add_u32 s80, s87, 96256
    buffer_store_dwordx4 v[88:91], v4, s[12:15], s80 offen sc1
    s_waitcnt vmcnt(0) lgkmcnt(0)
    s_branch L_p5j_26
L_one_25:
    ds_read_b64 v[96:97], v23 offset:0
    ds_read_b64 v[98:99], v23 offset:512
    ds_read_b64 v[100:101], v23 offset:128
    ds_read_b64 v[102:103], v23 offset:640
    ds_read_b64 v[104:105], v23 offset:256
    ds_read_b64 v[106:107], v23 offset:768
    ds_read_b64 v[108:109], v23 offset:384
    ds_read_b64 v[110:111], v23 offset:896
    ds_read_b128 v[64:67], v5 offset:0
    ds_read_b128 v[68:71], v5 offset:256
    ds_read_b128 v[72:75], v5 offset:32768
    ds_read_b128 v[76:79], v5 offset:33024
    ds_read_b128 v[80:83], v5 offset:2048
    ds_read_b128 v[84:87], v5 offset:2304
    ds_read_b128 v[88:91], v5 offset:34816
    ds_read_b128 v[92:95], v5 offset:35072
    s_waitcnt lgkmcnt(8)
    v_pk_add_f32 v[96:97], v[96:97], v[98:99]
    v_mul_f32 v120, 0x3b000000, v96
    v_mul_f32 v121, 0x3b000000, v97
    v_fma_f32 v121, -v120, v120, v121
    v_max_f32 v121, 0, v121
    v_add_f32 v121, 0x3727c5ac, v121
    v_rsq_f32 v121, v121
    v_pk_add_f32 v[100:101], v[100:101], v[102:103]
    v_mul_f32 v122, 0x3b000000, v100
    v_mul_f32 v123, 0x3b000000, v101
    v_fma_f32 v123, -v122, v122, v123
    v_max_f32 v123, 0, v123
    v_add_f32 v123, 0x3727c5ac, v123
    v_rsq_f32 v123, v123
    v_pk_add_f32 v[104:105], v[104:105], v[106:107]
    v_mul_f32 v124, 0x3b000000, v104
    v_mul_f32 v125, 0x3b000000, v105
    v_fma_f32 v125, -v124, v124, v125
    v_max_f32 v125, 0, v125
    v_add_f32 v125, 0x3727c5ac, v125
    v_rsq_f32 v125, v125
    v_pk_add_f32 v[108:109], v[108:109], v[110:111]
    v_mul_f32 v126, 0x3b000000, v108
    v_mul_f32 v127, 0x3b000000, v109
    v_fma_f32 v127, -v126, v126, v127
    v_max_f32 v127, 0, v127
    v_add_f32 v127, 0x3727c5ac, v127
    v_rsq_f32 v127, v127
    s_waitcnt lgkmcnt(4)
    v_mfma_f32_16x16x32_bf16 v[32:35], v[128:131], v[64:67], 0
    v_mfma_f32_16x16x32_bf16 v[36:39], v[128:131], v[68:71], 0
    v_mfma_f32_16x16x32_bf16 v[40:43], v[128:131], v[72:75], 0
    v_mfma_f32_16x16x32_bf16 v[44:47], v[128:131], v[76:79], 0
    s_add_u32 s69, s71, 0
    buffer_load_dwordx4 v[192:195], v4, s[12:15], s69 offen sc1
    ds_read_b128 v[96:99], v5 offset:4096
    ds_read_b128 v[100:103], v5 offset:4352
    ds_read_b128 v[104:107], v5 offset:36864
    ds_read_b128 v[108:111], v5 offset:37120
    s_waitcnt lgkmcnt(4)
    v_mfma_f32_16x16x32_bf16 v[32:35], v[132:135], v[80:83], v[32:35]
    v_mfma_f32_16x16x32_bf16 v[36:39], v[132:135], v[84:87], v[36:39]
    v_mfma_f32_16x16x32_bf16 v[40:43], v[132:135], v[88:91], v[40:43]
    v_mfma_f32_16x16x32_bf16 v[44:47], v[132:135], v[92:95], v[44:47]
    buffer_load_dwordx4 v[196:199], v4, s[12:15], s69 offen offset:1024 sc1
    ds_read_b128 v[64:67], v5 offset:6144
    ds_read_b128 v[68:71], v5 offset:6400
    ds_read_b128 v[72:75], v5 offset:38912
    ds_read_b128 v[76:79], v5 offset:39168
    s_waitcnt lgkmcnt(4)
    v_mfma_f32_16x16x32_bf16 v[32:35], v[136:139], v[96:99], v[32:35]
    v_mfma_f32_16x16x32_bf16 v[36:39], v[136:139], v[100:103], v[36:39]
    v_mfma_f32_16x16x32_bf16 v[40:43], v[136:139], v[104:107], v[40:43]
    v_mfma_f32_16x16x32_bf16 v[44:47], v[136:139], v[108:111], v[44:47]
    buffer_load_dwordx4 v[200:203], v4, s[12:15], s69 offen offset:2048 sc1
    ds_read_b128 v[80:83], v5 offset:8192
    ds_read_b128 v[84:87], v5 offset:8448
    ds_read_b128 v[88:91], v5 offset:40960
    ds_read_b128 v[92:95], v5 offset:41216
    s_waitcnt lgkmcnt(4)
    v_mfma_f32_16x16x32_bf16 v[32:35], v[140:143], v[64:67], v[32:35]
    v_mfma_f32_16x16x32_bf16 v[36:39], v[140:143], v[68:71], v[36:39]
    v_mfma_f32_16x16x32_bf16 v[40:43], v[140:143], v[72:75], v[40:43]
    v_mfma_f32_16x16x32_bf16 v[44:47], v[140:143], v[76:79], v[44:47]
    buffer_load_dwordx4 v[204:207], v4, s[12:15], s69 offen offset:3072 sc1
    ds_read_b128 v[96:99], v5 offset:10240
    ds_read_b128 v[100:103], v5 offset:10496
    ds_read_b128 v[104:107], v5 offset:43008
    ds_read_b128 v[108:111], v5 offset:43264
    s_waitcnt lgkmcnt(4)
    v_mfma_f32_16x16x32_bf16 v[32:35], v[144:147], v[80:83], v[32:35]
    v_mfma_f32_16x16x32_bf16 v[36:39], v[144:147], v[84:87], v[36:39]
    v_mfma_f32_16x16x32_bf16 v[40:43], v[144:147], v[88:91], v[40:43]
    v_mfma_f32_16x16x32_bf16 v[44:47], v[144:147], v[92:95], v[44:47]
    s_add_u32 s69, s71, 4096
    buffer_load_dwordx4 v[208:211], v4, s[12:15], s69 offen sc1
    ds_read_b128 v[64:67], v5 offset:12288
    ds_read_b128 v[68:71], v5 offset:12544
    ds_read_b128 v[72:75], v5 offset:45056
    ds_read_b128 v[76:79], v5 offset:45312
    s_waitcnt lgkmcnt(4)
    v_mfma_f32_16x16x32_bf16 v[32:35], v[148:151], v[96:99], v[32:35]
    v_mfma_f32_16x16x32_bf16 v[36:39], v[148:151], v[100:103], v[36:39]
    v_mfma_f32_16x16x32_bf16 v[40:43], v[148:151], v[104:107], v[40:43]
    v_mfma_f32_16x16x32_bf16 v[44:47], v[148:151], v[108:111], v[44:47]
    buffer_load_dwordx4 v[212:215], v4, s[12:15], s69 offen offset:1024 sc1
    ds_read_b128 v[80:83], v5 offset:14336
    ds_read_b128 v[84:87], v5 offset:14592
    ds_read_b128 v[88:91], v5 offset:47104
    ds_read_b128 v[92:95], v5 offset:47360
    s_waitcnt lgkmcnt(4)
    v_mfma_f32_16x16x32_bf16 v[32:35], v[152:155], v[64:67], v[32:35]
    v_mfma_f32_16x16x32_bf16 v[36:39], v[152:155], v[68:71], v[36:39]
    v_mfma_f32_16x16x32_bf16 v[40:43], v[152:155], v[72:75], v[40:43]
    v_mfma_f32_16x16x32_bf16 v[44:47], v[152:155], v[76:79], v[44:47]
    buffer_load_dwordx4 v[216:219], v4, s[12:15], s69 offen offset:2048 sc1
    ds_read_b128 v[96:99], v5 offset:16384
    ds_read_b128 v[100:103], v5 offset:16640
    ds_read_b128 v[104:107], v5 offset:49152
    ds_read_b128 v[108:111], v5 offset:49408
    s_waitcnt lgkmcnt(4)
    v_mfma_f32_16x16x32_bf16 v[32:35], v[156:159], v[80:83], v[32:35]
    v_mfma_f32_16x16x32_bf16 v[36:39], v[156:159], v[84:87], v[36:39]
    v_mfma_f32_16x16x32_bf16 v[40:43], v[156:159], v[88:91], v[40:43]
    v_mfma_f32_16x16x32_bf16 v[44:47], v[156:159], v[92:95], v[44:47]
    buffer_load_dwordx4 v[220:223], v4, s[12:15], s69 offen offset:3072 sc1
    ds_read_b128 v[64:67], v5 offset:18432
    ds_read_b128 v[68:71], v5 offset:18688
    ds_read_b128 v[72:75], v5 offset:51200
    ds_read_b128 v[76:79], v5 offset:51456
    s_waitcnt lgkmcnt(4)
    v_mfma_f32_16x16x32_bf16 v[32:35], v[160:163], v[96:99], v[32:35]
    v_mfma_f32_16x16x32_bf16 v[36:39], v[160:163], v[100:103], v[36:39]
    v_mfma_f32_16x16x32_bf16 v[40:43], v[160:163], v[104:107], v[40:43]
    v_mfma_f32_16x16x32_bf16 v[44:47], v[160:163], v[108:111], v[44:47]
    s_add_u32 s69, s71, 8192
    buffer_load_dwordx4 v[224:227], v4, s[12:15], s69 offen sc1
    ds_read_b128 v[80:83], v5 offset:20480
    ds_read_b128 v[84:87], v5 offset:20736
    ds_read_b128 v[88:91], v5 offset:53248
    ds_read_b128 v[92:95], v5 offset:53504
    v_lshlrev_b32 v14, 7, v1
    s_mul_i32 s80, s7, 44032
    s_sub_u32 s81, s5, 2
    s_lshl_b32 s81, s81, 13
    s_add_u32 s80, s80, s81
    s_add_u32 s80, s80, 15826944
    s_cmp_ge_u32 s5, 2
    s_cselect_b64 exec, -1, 0
    buffer_load_dword v15, v14, s[12:15], s80 offen
    s_mov_b64 exec, -1
    s_waitcnt lgkmcnt(4)
    v_mfma_f32_16x16x32_bf16 v[32:35], v[164:167], v[64:67], v[32:35]
    v_mfma_f32_16x16x32_bf16 v[36:39], v[164:167], v[68:71], v[36:39]
    v_mfma_f32_16x16x32_bf16 v[40:43], v[164:167], v[72:75], v[40:43]
    v_mfma_f32_16x16x32_bf16 v[44:47], v[164:167], v[76:79], v[44:47]
    buffer_load_dwordx4 v[228:231], v4, s[12:15], s69 offen offset:1024 sc1
    ds_read_b128 v[96:99], v5 offset:22528
    ds_read_b128 v[100:103], v5 offset:22784
    ds_read_b128 v[104:107], v5 offset:55296
    ds_read_b128 v[108:111], v5 offset:55552
    s_waitcnt lgkmcnt(4)
    v_mfma_f32_16x16x32_bf16 v[32:35], v[168:171], v[80:83], v[32:35]
    v_mfma_f32_16x16x32_bf16 v[36:39], v[168:171], v[84:87], v[36:39]
    v_mfma_f32_16x16x32_bf16 v[40:43], v[168:171], v[88:91], v[40:43]
    v_mfma_f32_16x16x32_bf16 v[44:47], v[168:171], v[92:95], v[44:47]
    buffer_load_dwordx4 v[232:235], v4, s[12:15], s69 offen offset:2048 sc1
    ds_read_b128 v[64:67], v5 offset:24576
    ds_read_b128 v[68:71], v5 offset:24832
    ds_read_b128 v[72:75], v5 offset:57344
    ds_read_b128 v[76:79], v5 offset:57600
    s_waitcnt lgkmcnt(4)
    v_mfma_f32_16x16x32_bf16 v[32:35], v[172:175], v[96:99], v[32:35]
    v_mfma_f32_16x16x32_bf16 v[36:39], v[172:175], v[100:103], v[36:39]
    v_mfma_f32_16x16x32_bf16 v[40:43], v[172:175], v[104:107], v[40:43]
    v_mfma_f32_16x16x32_bf16 v[44:47], v[172:175], v[108:111], v[44:47]
    buffer_load_dwordx4 v[236:239], v4, s[12:15], s69 offen offset:3072 sc1
    ds_read_b128 v[80:83], v5 offset:26624
    ds_read_b128 v[84:87], v5 offset:26880
    ds_read_b128 v[88:91], v5 offset:59392
    ds_read_b128 v[92:95], v5 offset:59648
    s_waitcnt lgkmcnt(4)
    v_mfma_f32_16x16x32_bf16 v[32:35], v[176:179], v[64:67], v[32:35]
    v_mfma_f32_16x16x32_bf16 v[36:39], v[176:179], v[68:71], v[36:39]
    v_mfma_f32_16x16x32_bf16 v[40:43], v[176:179], v[72:75], v[40:43]
    v_mfma_f32_16x16x32_bf16 v[44:47], v[176:179], v[76:79], v[44:47]
    s_add_u32 s69, s71, 12288
    buffer_load_dwordx4 v[240:243], v4, s[12:15], s69 offen sc1
    ds_read_b128 v[96:99], v5 offset:28672
    ds_read_b128 v[100:103], v5 offset:28928
    ds_read_b128 v[104:107], v5 offset:61440
    ds_read_b128 v[108:111], v5 offset:61696
    s_waitcnt lgkmcnt(4)
    v_mfma_f32_16x16x32_bf16 v[32:35], v[180:183], v[80:83], v[32:35]
    v_mfma_f32_16x16x32_bf16 v[36:39], v[180:183], v[84:87], v[36:39]
    v_mfma_f32_16x16x32_bf16 v[40:43], v[180:183], v[88:91], v[40:43]
    v_mfma_f32_16x16x32_bf16 v[44:47], v[180:183], v[92:95], v[44:47]
    buffer_load_dwordx4 v[244:247], v4, s[12:15], s69 offen offset:1024 sc1
    ds_read_b128 v[64:67], v5 offset:30720
    ds_read_b128 v[68:71], v5 offset:30976
    ds_read_b128 v[72:75], v5 offset:63488
    ds_read_b128 v[76:79], v5 offset:63744
    s_waitcnt lgkmcnt(4)
    v_mfma_f32_16x16x32_bf16 v[32:35], v[184:187], v[96:99], v[32:35]
    v_mfma_f32_16x16x32_bf16 v[36:39], v[184:187], v[100:103], v[36:39]
    v_mfma_f32_16x16x32_bf16 v[40:43], v[184:187], v[104:107], v[40:43]
    v_mfma_f32_16x16x32_bf16 v[44:47], v[184:187], v[108:111], v[44:47]
    buffer_load_dwordx4 v[248:251], v4, s[12:15], s69 offen offset:2048 sc1
    s_waitcnt lgkmcnt(0)
    v_mfma_f32_16x16x32_bf16 v[32:35], v[188:191], v[64:67], v[32:35]
    v_mfma_f32_16x16x32_bf16 v[36:39], v[188:191], v[68:71], v[36:39]
    v_mfma_f32_16x16x32_bf16 v[40:43], v[188:191], v[72:75], v[40:43]
    v_mfma_f32_16x16x32_bf16 v[44:47], v[188:191], v[76:79], v[44:47]
    buffer_load_dwordx4 v[252:255], v4, s[12:15], s69 offen offset:3072 sc1
    s_add_u32 s69, s71, 16384
    buffer_load_dwordx4 v[128:131], v4, s[12:15], s69 offen sc1
    buffer_load_dwordx4 v[132:135], v4, s[12:15], s69 offen offset:1024 sc1
    buffer_load_dwordx4 v[136:139], v4, s[12:15], s69 offen offset:2048 sc1
    buffer_load_dwordx4 v[140:143], v4, s[12:15], s69 offen offset:3072 sc1
    s_add_u32 s69, s71, 20480
    buffer_load_dwordx4 v[144:147], v4, s[12:15], s69 offen sc1
    s_add_u32 s82, s71, s70
    buffer_load_dwordx4 v[148:151], v4, s[12:15], s82 offen sc1
    v_mov_b32 v64, 0xc0135761
    v_mov_b32 v66, 0xbdd2d3e8
    v_mov_b32 v68, 0x3f800000
    v_pk_fma_f32 v[32:33], v[24:25], v[120:121], v[32:33] op_sel_hi:[1,0,1] neg_lo:[0,1,0] neg_hi:[0,1,0]
    v_pk_fma_f32 v[34:35], v[26:27], v[120:121], v[34:35] op_sel_hi:[1,0,1] neg_lo:[0,1,0] neg_hi:[0,1,0]
    v_pk_fma_f32 v[36:37], v[24:25], v[122:123], v[36:37] op_sel_hi:[1,0,1] neg_lo:[0,1,0] neg_hi:[0,1,0]
    v_pk_fma_f32 v[38:39], v[26:27], v[122:123], v[38:39] op_sel_hi:[1,0,1] neg_lo:[0,1,0] neg_hi:[0,1,0]
    v_pk_mul_f32 v[32:33], v[32:33], v[120:121] op_sel:[0,1] op_sel_hi:[1,1]
    v_pk_mul_f32 v[34:35], v[34:35], v[120:121] op_sel:[0,1] op_sel_hi:[1,1]
    v_pk_mul_f32 v[36:37], v[36:37], v[122:123] op_sel:[0,1] op_sel_hi:[1,1]
    v_pk_mul_f32 v[38:39], v[38:39], v[122:123] op_sel:[0,1] op_sel_hi:[1,1]
    v_pk_mul_f32 v[96:97], v[32:33], v[32:33]
    v_pk_mul_f32 v[98:99], v[34:35], v[34:35]
    v_pk_mul_f32 v[100:101], v[36:37], v[36:37]
    v_pk_mul_f32 v[102:103], v[38:39], v[38:39]
    v_pk_fma_f32 v[96:97], v[96:97], v[66:67], v[64:65] op_sel_hi:[1,0,0]
    v_pk_fma_f32 v[98:99], v[98:99], v[66:67], v[64:65] op_sel_hi:[1,0,0]
    v_pk_fma_f32 v[100:101], v[100:101], v[66:67], v[64:65] op_sel_hi:[1,0,0]
    v_pk_fma_f32 v[102:103], v[102:103], v[66:67], v[64:65] op_sel_hi:[1,0,0]
    v_pk_mul_f32 v[96:97], v[96:97], v[32:33]
    v_pk_mul_f32 v[98:99], v[98:99], v[34:35]
    v_pk_mul_f32 v[100:101], v[100:101], v[36:37]
    v_pk_mul_f32 v[102:103], v[102:103], v[38:39]
    v_exp_f32 v96, v96
    v_exp_f32 v98, v98
    v_exp_f32 v100, v100
    v_exp_f32 v102, v102
    v_exp_f32 v97, v97
    v_exp_f32 v99, v99
    v_exp_f32 v101, v101
    v_exp_f32 v103, v103
    v_pk_add_f32 v[96:97], v[96:97], v[68:69] op_sel_hi:[1,0]
    v_pk_add_f32 v[98:99], v[98:99], v[68:69] op_sel_hi:[1,0]
    v_pk_add_f32 v[100:101], v[100:101], v[68:69] op_sel_hi:[1,0]
    v_pk_add_f32 v[102:103], v[102:103], v[68:69] op_sel_hi:[1,0]
    v_rcp_f32 v96, v96
    v_rcp_f32 v98, v98
    v_rcp_f32 v100, v100
    v_rcp_f32 v102, v102
    v_rcp_f32 v97, v97
    v_rcp_f32 v99, v99
    v_rcp_f32 v101, v101
    v_rcp_f32 v103, v103
    v_pk_mul_f32 v[32:33], v[32:33], v[96:97]
    v_pk_mul_f32 v[34:35], v[34:35], v[98:99]
    v_pk_mul_f32 v[36:37], v[36:37], v[100:101]
    v_pk_mul_f32 v[38:39], v[38:39], v[102:103]
    v_cvt_pk_bf16_f32 v76, v32, v33
    v_cvt_pk_bf16_f32 v78, v36, v37
    v_cvt_pk_bf16_f32 v77, v34, v35
    v_cvt_pk_bf16_f32 v79, v38, v39
    v_permlane16_swap_b32 v76, v78
    s_nop 0
    v_permlane16_swap_b32 v77, v79
    s_add_u32 s80, s87, 0
    buffer_store_dwordx4 v[76:79], v4, s[12:15], s80 offen sc1
    v_pk_fma_f32 v[40:41], v[24:25], v[124:125], v[40:41] op_sel_hi:[1,0,1] neg_lo:[0,1,0] neg_hi:[0,1,0]
    v_pk_fma_f32 v[42:43], v[26:27], v[124:125], v[42:43] op_sel_hi:[1,0,1] neg_lo:[0,1,0] neg_hi:[0,1,0]
    v_pk_fma_f32 v[44:45], v[24:25], v[126:127], v[44:45] op_sel_hi:[1,0,1] neg_lo:[0,1,0] neg_hi:[0,1,0]
    v_pk_fma_f32 v[46:47], v[26:27], v[126:127], v[46:47] op_sel_hi:[1,0,1] neg_lo:[0,1,0] neg_hi:[0,1,0]
    v_pk_mul_f32 v[40:41], v[40:41], v[124:125] op_sel:[0,1] op_sel_hi:[1,1]
    v_pk_mul_f32 v[42:43], v[42:43], v[124:125] op_sel:[0,1] op_sel_hi:[1,1]
    v_pk_mul_f32 v[44:45], v[44:45], v[126:127] op_sel:[0,1] op_sel_hi:[1,1]
    v_pk_mul_f32 v[46:47], v[46:47], v[126:127] op_sel:[0,1] op_sel_hi:[1,1]
    v_pk_mul_f32 v[96:97], v[40:41], v[40:41]
    v_pk_mul_f32 v[98:99], v[42:43], v[42:43]
    v_pk_mul_f32 v[100:101], v[44:45], v[44:45]
    v_pk_mul_f32 v[102:103], v[46:47], v[46:47]
    v_pk_fma_f32 v[96:97], v[96:97], v[66:67], v[64:65] op_sel_hi:[1,0,0]
    v_pk_fma_f32 v[98:99], v[98:99], v[66:67], v[64:65] op_sel_hi:[1,0,0]
    v_pk_fma_f32 v[100:101], v[100:101], v[66:67], v[64:65] op_sel_hi:[1,0,0]
    v_pk_fma_f32 v[102:103], v[102:103], v[66:67], v[64:65] op_sel_hi:[1,0,0]
    v_pk_mul_f32 v[96:97], v[96:97], v[40:41]
    v_pk_mul_f32 v[98:99], v[98:99], v[42:43]
    v_pk_mul_f32 v[100:101], v[100:101], v[44:45]
    v_pk_mul_f32 v[102:103], v[102:103], v[46:47]
    v_exp_f32 v96, v96
    v_exp_f32 v98, v98
    v_exp_f32 v100, v100
    v_exp_f32 v102, v102
    v_exp_f32 v97, v97
    v_exp_f32 v99, v99
    v_exp_f32 v101, v101
    v_exp_f32 v103, v103
    v_pk_add_f32 v[96:97], v[96:97], v[68:69] op_sel_hi:[1,0]
    v_pk_add_f32 v[98:99], v[98:99], v[68:69] op_sel_hi:[1,0]
    v_pk_add_f32 v[100:101], v[100:101], v[68:69] op_sel_hi:[1,0]
    v_pk_add_f32 v[102:103], v[102:103], v[68:69] op_sel_hi:[1,0]
    v_rcp_f32 v96, v96
    v_rcp_f32 v98, v98
    v_rcp_f32 v100, v100
    v_rcp_f32 v102, v102
    v_rcp_f32 v97, v97
    v_rcp_f32 v99, v99
    v_rcp_f32 v101, v101
    v_rcp_f32 v103, v103
    v_pk_mul_f32 v[40:41], v[40:41], v[96:97]
    v_pk_mul_f32 v[42:43], v[42:43], v[98:99]
    v_pk_mul_f32 v[44:45], v[44:45], v[100:101]
    v_pk_mul_f32 v[46:47], v[46:47], v[102:103]
    v_cvt_pk_bf16_f32 v80, v40, v41
    v_cvt_pk_bf16_f32 v82, v44, v45
    v_cvt_pk_bf16_f32 v81, v42, v43
    v_cvt_pk_bf16_f32 v83, v46, v47
    v_permlane16_swap_b32 v80, v82
    s_nop 0
    v_permlane16_swap_b32 v81, v83
    s_add_u32 s80, s87, 88064
    buffer_store_dwordx4 v[80:83], v4, s[12:15], s80 offen sc1
    s_waitcnt vmcnt(0) lgkmcnt(0)
L_p5j_26:
    s_setprio 0
    s_barrier
    s_lshl_b32 s87, s77, 3
    s_add_u32 s87, s87, s78
    s_lshl_b32 s80, s87, 6
    s_add_u32 s80, s80, 327680
    v_mov_b32 v14, s4
    v_mov_b32 v15, 0
    s_cmp_eq_u32 s5, 0
    s_cselect_b64 exec, 1, 0
    buffer_store_dword v14, v15, s[12:15], s80 offen sc1
    s_mov_b64 exec, -1
    s_cmp_eq_u32 s89, 1
    s_cbranch_scc1 L_w4one_27
    s_add_u32 s69, s71, 0
    buffer_load_dwordx4 v[192:195], v4, s[12:15], s69 offen sc1
    buffer_load_dwordx4 v[196:199], v4, s[12:15], s69 offen offset:1024 sc1
    buffer_load_dwordx4 v[200:203], v4, s[12:15], s69 offen offset:2048 sc1
    buffer_load_dwordx4 v[204:207], v4, s[12:15], s69 offen offset:3072 sc1
    s_add_u32 s69, s71, 4096
    buffer_load_dwordx4 v[208:211], v4, s[12:15], s69 offen sc1
    buffer_load_dwordx4 v[212:215], v4, s[12:15], s69 offen offset:1024 sc1
    buffer_load_dwordx4 v[216:219], v4, s[12:15], s69 offen offset:2048 sc1
    buffer_load_dwordx4 v[220:223], v4, s[12:15], s69 offen offset:3072 sc1
    s_add_u32 s69, s71, 8192
    buffer_load_dwordx4 v[224:227], v4, s[12:15], s69 offen sc1
    buffer_load_dwordx4 v[228:231], v4, s[12:15], s69 offen offset:1024 sc1
    buffer_load_dwordx4 v[232:235], v4, s[12:15], s69 offen offset:2048 sc1
    buffer_load_dwordx4 v[236:239], v4, s[12:15], s69 offen offset:3072 sc1
    s_add_u32 s69, s71, 12288
    buffer_load_dwordx4 v[240:243], v4, s[12:15], s69 offen sc1
    buffer_load_dwordx4 v[244:247], v4, s[12:15], s69 offen offset:1024 sc1
    buffer_load_dwordx4 v[248:251], v4, s[12:15], s69 offen offset:2048 sc1
    buffer_load_dwordx4 v[252:255], v4, s[12:15], s69 offen offset:3072 sc1
    s_add_u32 s69, s71, 16384
    buffer_load_dwordx4 v[128:131], v4, s[12:15], s69 offen sc1
    buffer_load_dwordx4 v[132:135], v4, s[12:15], s69 offen offset:1024 sc1
    buffer_load_dwordx4 v[136:139], v4, s[12:15], s69 offen offset:2048 sc1
    buffer_load_dwordx4 v[140:143], v4, s[12:15], s69 offen offset:3072 sc1
    s_add_u32 s69, s71, 20480
    buffer_load_dwordx4 v[144:147], v4, s[12:15], s69 offen sc1
    s_add_u32 s82, s71, s70
    buffer_load_dwordx4 v[148:151], v4, s[12:15], s82 offen sc1
L_w4one_27:
    s_lshl_b32 s80, s78, 6
    s_lshl_b32 s81, s85, 4
    s_add_u32 s80, s80, s81
    s_lshl_b32 s80, s80, 2
    s_add_u32 s80, s80, 247808
    v_lshlrev_b32 v14, 4, v3
    buffer_load_dwordx4 v[16:19], v14, s[12:15], s80 offen sc1
    s_cmp_lg_u32 s5, 7
    s_cbranch_scc1 L_pollskip_28
    v_and_b32 v116, 7, v1
    s_lshl_b32 s80, s77, 3
    v_add_u32 v116, s80, v116
    v_lshlrev_b32 v116, 6, v116
    s_mov_b32 s84, 0
L_poll_29:
    s_mov_b32 s81, 327680
    buffer_load_dword v118, v116, s[12:15], s81 offen sc1
    s_waitcnt vmcnt(0)
    v_cmp_ne_u32 vcc, s4, v118
    s_nop 0
    s_cbranch_vccz L_pollok_30
    s_add_u32 s84, s84, 1
    s_cmp_lt_u32 s84, 20000
    s_cbranch_scc1 L_poll_29
L_pollok_30:
L_pollskip_28:
    s_barrier
    s_lshl_b32 s80, s77, 1
    s_lshr_b32 s81, s5, 1
    s_and_b32 s81, s81, 1
    s_add_u32 s80, s80, s81
    s_mul_i32 s80, s80, 88064
    s_mul_i32 s81, s86, 45056
    s_add_u32 s80, s80, s81
    s_and_b32 s81, s5, 1
    s_lshl_b32 s81, s81, 10
    s_add_u32 s80, s80, s81
    s_add_u32 s87, s80, 7733248
    s_lshl_b32 s88, s5, 10
    s_add_u32 s82, s87, 0
    s_add_u32 s83, s88, 0
    s_mov_b32 m0, s83
    s_nop 0
    buffer_load_dwordx4 v4, s[12:15], s82 offen sc1 lds
    s_add_u32 s82, s87, 2048
    s_add_u32 s83, s88, 8192
    s_mov_b32 m0, s83
    s_nop 0
    buffer_load_dwordx4 v4, s[12:15], s82 offen sc1 lds
    s_add_u32 s82, s87, 4096
    s_add_u32 s83, s88, 16384
    s_mov_b32 m0, s83
    s_nop 0
    buffer_load_dwordx4 v4, s[12:15], s82 offen sc1 lds
    s_add_u32 s82, s87, 6144
    s_add_u32 s83, s88, 24576
    s_mov_b32 m0, s83
    s_nop 0
    buffer_load_dwordx4 v4, s[12:15], s82 offen sc1 lds
    s_add_u32 s82, s87, 8192
    s_add_u32 s83, s88, 32768
    s_mov_b32 m0, s83
    s_nop 0
    buffer_load_dwordx4 v4, s[12:15], s82 offen sc1 lds
    s_add_u32 s82, s87, 10240
    s_add_u32 s83, s88, 40960
    s_mov_b32 m0, s83
    s_nop 0
    buffer_load_dwordx4 v4, s[12:15], s82 offen sc1 lds
    s_add_u32 s82, s87, 12288
    s_add_u32 s83, s88, 49152
    s_mov_b32 m0, s83
    s_nop 0
    buffer_load_dwordx4 v4, s[12:15], s82 offen sc1 lds
    s_add_u32 s82, s87, 14336
    s_add_u32 s83, s88, 57344
    s_mov_b32 m0, s83
    s_nop 0
    buffer_load_dwordx4 v4, s[12:15], s82 offen sc1 lds
    s_lshl_b32 s80, s86, 12
    v_add_u32 v32, s80, v5
    v_add_u32 v33, 65536, v32
    v_add_u32 v34, 131072, v32
    s_waitcnt vmcnt(5)
    s_barrier
    ds_read_b128 v[64:67], v32 offset:0
    ds_read_b128 v[68:71], v32 offset:256
    ds_read_b128 v[72:75], v32 offset:2048
    ds_read_b128 v[76:79], v32 offset:2304
    ds_read_b128 v[80:83], v32 offset:8192
    ds_read_b128 v[84:87], v32 offset:8448
    ds_read_b128 v[88:91], v32 offset:10240
    ds_read_b128 v[92:95], v32 offset:10496
    ds_read_b128 v[96:99], v32 offset:16384
    ds_read_b128 v[100:103], v32 offset:16640
    ds_read_b128 v[104:107], v32 offset:18432
    ds_read_b128 v[108:111], v32 offset:18688
    s_add_u32 s82, s87, 16384
    s_add_u32 s83, s88, 65536
    s_mov_b32 m0, s83
    s_nop 0
    buffer_load_dwordx4 v4, s[12:15], s82 offen sc1 lds
    s_add_u32 s82, s87, 18432
    s_add_u32 s83, s88, 73728
    s_mov_b32 m0, s83
    s_nop 0
    buffer_load_dwordx4 v4, s[12:15], s82 offen sc1 lds
    s_waitcnt lgkmcnt(8)
    v_mfma_f32_16x16x32_bf16 v[40:43], v[192:195], v[64:67], 0
    v_mfma_f32_16x16x32_bf16 v[44:47], v[192:195], v[68:71], 0
    v_mfma_f32_16x16x32_bf16 v[48:51], v[192:195], v[72:75], 0
    v_mfma_f32_16x16x32_bf16 v[52:55], v[192:195], v[76:79], 0
    s_add_u32 s82, s87, 20480
    s_add_u32 s83, s88, 81920
    s_mov_b32 m0, s83
    s_nop 0
    buffer_load_dwordx4 v4, s[12:15], s82 offen sc1 lds
    s_add_u32 s82, s87, 22528
    s_add_u32 s83, s88, 90112
    s_mov_b32 m0, s83
    s_nop 0
    buffer_load_dwordx4 v4, s[12:15], s82 offen sc1 lds
    s_waitcnt lgkmcnt(4)
    v_mfma_f32_16x16x32_bf16 v[40:43], v[196:199], v[80:83], v[40:43]
    v_mfma_f32_16x16x32_bf16 v[44:47], v[196:199], v[84:87], v[44:47]
    v_mfma_f32_16x16x32_bf16 v[48:51], v[196:199], v[88:91], v[48:51]
    v_mfma_f32_16x16x32_bf16 v[52:55], v[196:199], v[92:95], v[52:55]
    s_waitcnt vmcnt(4)
    s_barrier
    ds_read_b128 v[112:115], v32 offset:24576
    ds_read_b128 v[116:119], v32 offset:24832
    ds_read_b128 v[120:123], v32 offset:26624
    ds_read_b128 v[124:127], v32 offset:26880
    ds_read_b128 v[64:67], v32 offset:32768
    ds_read_b128 v[68:71], v32 offset:33024
    ds_read_b128 v[72:75], v32 offset:34816
    ds_read_b128 v[76:79], v32 offset:35072
    s_add_u32 s82, s87, 24576
    s_add_u32 s83, s88, 98304
    s_mov_b32 m0, s83
    s_nop 0
    buffer_load_dwordx4 v4, s[12:15], s82 offen sc1 lds
    s_add_u32 s82, s87, 26624
    s_add_u32 s83, s88, 106496
    s_mov_b32 m0, s83
    s_nop 0
    buffer_load_dwordx4 v4, s[12:15], s82 offen sc1 lds
    s_waitcnt lgkmcnt(8)
    v_mfma_f32_16x16x32_bf16 v[40:43], v[200:203], v[96:99], v[40:43]
    v_mfma_f32_16x16x32_bf16 v[44:47], v[200:203], v[100:103], v[44:47]
    v_mfma_f32_16x16x32_bf16 v[48:51], v[200:203], v[104:107], v[48:51]
    v_mfma_f32_16x16x32_bf16 v[52:55], v[200:203], v[108:111], v[52:55]
    ds_read_b128 v[80:83], v32 offset:40960
    ds_read_b128 v[84:87], v32 offset:41216
    ds_read_b128 v[88:91], v32 offset:43008
    ds_read_b128 v[92:95], v32 offset:43264
    s_add_u32 s82, s87, 28672
    s_add_u32 s83, s88, 114688
    s_mov_b32 m0, s83
    s_nop 0
    buffer_load_dwordx4 v4, s[12:15], s82 offen sc1 lds
    s_add_u32 s82, s87, 30720
    s_add_u32 s83, s88, 122880
    s_mov_b32 m0, s83
    s_nop 0
    buffer_load_dwordx4 v4, s[12:15], s82 offen sc1 lds
    s_waitcnt lgkmcnt(8)
    v_mfma_f32_16x16x32_bf16 v[40:43], v[204:207], v[112:115], v[40:43]
    v_mfma_f32_16x16x32_bf16 v[44:47], v[204:207], v[116:119], v[44:47]
    v_mfma_f32_16x16x32_bf16 v[48:51], v[204:207], v[120:123], v[48:51]
    v_mfma_f32_16x16x32_bf16 v[52:55], v[204:207], v[124:127], v[52:55]
    ds_read_b128 v[96:99], v32 offset:49152
    ds_read_b128 v[100:103], v32 offset:49408
    ds_read_b128 v[104:107], v32 offset:51200
    ds_read_b128 v[108:111], v32 offset:51456
    s_add_u32 s82, s87, 32768
    s_add_u32 s83, s88, 131072
    s_mov_b32 m0, s83
    s_nop 0
    buffer_load_dwordx4 v4, s[12:15], s82 offen sc1 lds
    s_add_u32 s82, s87, 34816
    s_add_u32 s83, s88, 139264
    s_mov_b32 m0, s83
    s_nop 0
    buffer_load_dwordx4 v4, s[12:15], s82 offen sc1 lds
    s_waitcnt lgkmcnt(8)
    v_mfma_f32_16x16x32_bf16 v[40:43], v[208:211], v[64:67], v[40:43]
    v_mfma_f32_16x16x32_bf16 v[44:47], v[208:211], v[68:71], v[44:47]
    v_mfma_f32_16x16x32_bf16 v[48:51], v[208:211], v[72:75], v[48:51]
    v_mfma_f32_16x16x32_bf16 v[52:55], v[208:211], v[76:79], v[52:55]
    ds_read_b128 v[112:115], v32 offset:57344
    ds_read_b128 v[116:119], v32 offset:57600
    ds_read_b128 v[120:123], v32 offset:59392
    ds_read_b128 v[124:127], v32 offset:59648
    s_add_u32 s82, s87, 36864
    s_add_u32 s83, s88, 0
    s_mov_b32 m0, s83
    s_nop 0
    buffer_load_dwordx4 v4, s[12:15], s82 offen sc1 lds
    s_waitcnt lgkmcnt(8)
    v_mfma_f32_16x16x32_bf16 v[40:43], v[212:215], v[80:83], v[40:43]
    v_mfma_f32_16x16x32_bf16 v[44:47], v[212:215], v[84:87], v[44:47]
    v_mfma_f32_16x16x32_bf16 v[48:51], v[212:215], v[88:91], v[48:51]
    v_mfma_f32_16x16x32_bf16 v[52:55], v[212:215], v[92:95], v[52:55]
    s_add_u32 s82, s87, 38912
    s_add_u32 s83, s88, 8192
    s_mov_b32 m0, s83
    s_nop 0
    buffer_load_dwordx4 v4, s[12:15], s82 offen sc1 lds
    s_waitcnt lgkmcnt(4)
    v_mfma_f32_16x16x32_bf16 v[40:43], v[216:219], v[96:99], v[40:43]
    v_mfma_f32_16x16x32_bf16 v[44:47], v[216:219], v[100:103], v[44:47]
    v_mfma_f32_16x16x32_bf16 v[48:51], v[216:219], v[104:107], v[48:51]
    v_mfma_f32_16x16x32_bf16 v[52:55], v[216:219], v[108:111], v[52:55]
    s_waitcnt vmcnt(6)
    s_barrier
    ds_read_b128 v[64:67], v33 offset:0
    ds_read_b128 v[68:71], v33 offset:256
    ds_read_b128 v[72:75], v33 offset:2048
    ds_read_b128 v[76:79], v33 offset:2304
    ds_read_b128 v[80:83], v33 offset:8192
    ds_read_b128 v[84:87], v33 offset:8448
    ds_read_b128 v[88:91], v33 offset:10240
    ds_read_b128 v[92:95], v33 offset:10496
    s_add_u32 s82, s87, 40960
    s_add_u32 s83, s88, 16384
    s_mov_b32 m0, s83
    s_nop 0
    buffer_load_dwordx4 v4, s[12:15], s82 offen sc1 lds
    s_waitcnt lgkmcnt(8)
    v_mfma_f32_16x16x32_bf16 v[40:43], v[220:223], v[112:115], v[40:43]
    v_mfma_f32_16x16x32_bf16 v[44:47], v[220:223], v[116:119], v[44:47]
    v_mfma_f32_16x16x32_bf16 v[48:51], v[220:223], v[120:123], v[48:51]
    v_mfma_f32_16x16x32_bf16 v[52:55], v[220:223], v[124:127], v[52:55]
    ds_read_b128 v[96:99], v33 offset:16384
    ds_read_b128 v[100:103], v33 offset:16640
    ds_read_b128 v[104:107], v33 offset:18432
    ds_read_b128 v[108:111], v33 offset:18688
    s_add_u32 s82, s87, 43008
    s_cmp_eq_u32 s86, 1
    s_cselect_b32 s82, 0x7ff00000, s82
    s_add_u32 s83, s88, 24576
    s_mov_b32 m0, s83
    s_nop 0
    buffer_load_dwordx4 v4, s[12:15], s82 offen sc1 lds
    s_waitcnt lgkmcnt(8)
    v_mfma_f32_16x16x32_bf16 v[40:43], v[224:227], v[64:67], v[40:43]
    v_mfma_f32_16x16x32_bf16 v[44:47], v[224:227], v[68:71], v[44:47]
    v_mfma_f32_16x16x32_bf16 v[48:51], v[224:227], v[72:75], v[48:51]
    v_mfma_f32_16x16x32_bf16 v[52:55], v[224:227], v[76:79], v[52:55]
    ds_read_b128 v[112:115], v33 offset:24576
    ds_read_b128 v[116:119], v33 offset:24832
    ds_read_b128 v[120:123], v33 offset:26624
    ds_read_b128 v[124:127], v33 offset:26880
    s_waitcnt lgkmcnt(8)
    v_mfma_f32_16x16x32_bf16 v[40:43], v[228:231], v[80:83], v[40:43]
    v_mfma_f32_16x16x32_bf16 v[44:47], v[228:231], v[84:87], v[44:47]
    v_mfma_f32_16x16x32_bf16 v[48:51], v[228:231], v[88:91], v[48:51]
    v_mfma_f32_16x16x32_bf16 v[52:55], v[228:231], v[92:95], v[52:55]
    ds_read_b128 v[64:67], v33 offset:32768
    ds_read_b128 v[68:71], v33 offset:33024
    ds_read_b128 v[72:75], v33 offset:34816
    ds_read_b128 v[76:79], v33 offset:35072
    s_waitcnt lgkmcnt(8)
    v_mfma_f32_16x16x32_bf16 v[40:43], v[232:235], v[96:99], v[40:43]
    v_mfma_f32_16x16x32_bf16 v[44:47], v[232:235], v[100:103], v[44:47]
    v_mfma_f32_16x16x32_bf16 v[48:51], v[232:235], v[104:107], v[48:51]
    v_mfma_f32_16x16x32_bf16 v[52:55], v[232:235], v[108:111], v[52:55]
    ds_read_b128 v[80:83], v33 offset:40960
    ds_read_b128 v[84:87], v33 offset:41216
    ds_read_b128 v[88:91], v33 offset:43008
    ds_read_b128 v[92:95], v33 offset:43264
    s_waitcnt lgkmcnt(8)
    v_mfma_f32_16x16x32_bf16 v[40:43], v[236:239], v[112:115], v[40:43]
    v_mfma_f32_16x16x32_bf16 v[44:47], v[236:239], v[116:119], v[44:47]
    v_mfma_f32_16x16x32_bf16 v[48:51], v[236:239], v[120:123], v[48:51]
    v_mfma_f32_16x16x32_bf16 v[52:55], v[236:239], v[124:127], v[52:55]
    s_waitcnt lgkmcnt(4)
    v_mfma_f32_16x16x32_bf16 v[40:43], v[240:243], v[64:67], v[40:43]
    v_mfma_f32_16x16x32_bf16 v[44:47], v[240:243], v[68:71], v[44:47]
    v_mfma_f32_16x16x32_bf16 v[48:51], v[240:243], v[72:75], v[48:51]
    v_mfma_f32_16x16x32_bf16 v[52:55], v[240:243], v[76:79], v[52:55]
    v_lshlrev_b32 v152, 16, v10
    v_lshlrev_b32 v160, 16, v6
    v_and_b32 v153, 0xffff0000, v10
    v_and_b32 v161, 0xffff0000, v6
    v_lshlrev_b32 v154, 16, v11
    v_lshlrev_b32 v162, 16, v7
    v_and_b32 v155, 0xffff0000, v11
    v_and_b32 v163, 0xffff0000, v7
    v_lshlrev_b32 v156, 16, v12
    v_lshlrev_b32 v164, 16, v8
    v_and_b32 v157, 0xffff0000, v12
    v_and_b32 v165, 0xffff0000, v8
    v_lshlrev_b32 v158, 16, v13
    v_lshlrev_b32 v166, 16, v9
    v_and_b32 v159, 0xffff0000, v13
    v_and_b32 v167, 0xffff0000, v9
    s_lshl_b32 s80, s77, 6
    s_lshl_b32 s81, s86, 5
    s_add_u32 s80, s80, s81
    s_lshl_b32 s80, s80, 10
    s_lshl_b32 s81, s78, 7
    s_add_u32 s80, s80, s81
    s_lshl_b32 s81, s85, 5
    s_add_u32 s79, s80, s81
    v_lshlrev_b32 v36, 10, v2
    v_lshl_add_u32 v36, v3, 3, v36
    s_waitcnt vmcnt(0)
    s_barrier
    ds_read_b128 v[96:99], v33 offset:49152
    ds_read_b128 v[100:103], v33 offset:49408
    ds_read_b128 v[104:107], v33 offset:51200
    ds_read_b128 v[108:111], v33 offset:51456
    ds_read_b128 v[112:115], v33 offset:57344
    ds_read_b128 v[116:119], v33 offset:57600
    ds_read_b128 v[120:123], v33 offset:59392
    ds_read_b128 v[124:127], v33 offset:59648
    s_waitcnt lgkmcnt(8)
    v_mfma_f32_16x16x32_bf16 v[40:43], v[244:247], v[80:83], v[40:43]
    v_mfma_f32_16x16x32_bf16 v[44:47], v[244:247], v[84:87], v[44:47]
    v_mfma_f32_16x16x32_bf16 v[48:51], v[244:247], v[88:91], v[48:51]
    v_mfma_f32_16x16x32_bf16 v[52:55], v[244:247], v[92:95], v[52:55]
    ds_read_b128 v[64:67], v34 offset:0
    ds_read_b128 v[68:71], v34 offset:256
    ds_read_b128 v[72:75], v34 offset:2048
    ds_read_b128 v[76:79], v34 offset:2304
    s_waitcnt lgkmcnt(8)
    v_mfma_f32_16x16x32_bf16 v[40:43], v[248:251], v[96:99], v[40:43]
    v_mfma_f32_16x16x32_bf16 v[44:47], v[248:251], v[100:103], v[44:47]
    v_mfma_f32_16x16x32_bf16 v[48:51], v[248:251], v[104:107], v[48:51]
    v_mfma_f32_16x16x32_bf16 v[52:55], v[248:251], v[108:111], v[52:55]
    ds_read_b128 v[80:83], v34 offset:8192
    ds_read_b128 v[84:87], v34 offset:8448
    ds_read_b128 v[88:91], v34 offset:10240
    ds_read_b128 v[92:95], v34 offset:10496
    s_waitcnt lgkmcnt(8)
    v_mfma_f32_16x16x32_bf16 v[40:43], v[252:255], v[112:115], v[40:43]
    v_mfma_f32_16x16x32_bf16 v[44:47], v[252:255], v[116:119], v[44:47]
    v_mfma_f32_16x16x32_bf16 v[48:51], v[252:255], v[120:123], v[48:51]
    v_mfma_f32_16x16x32_bf16 v[52:55], v[252:255], v[124:127], v[52:55]
    ds_read_b128 v[96:99], v32 offset:0
    ds_read_b128 v[100:103], v32 offset:256
    ds_read_b128 v[104:107], v32 offset:2048
    ds_read_b128 v[108:111], v32 offset:2304
    s_waitcnt lgkmcnt(8)
    v_mfma_f32_16x16x32_bf16 v[40:43], v[128:131], v[64:67], v[40:43]
    v_mfma_f32_16x16x32_bf16 v[44:47], v[128:131], v[68:71], v[44:47]
    v_mfma_f32_16x16x32_bf16 v[48:51], v[128:131], v[72:75], v[48:51]
    v_mfma_f32_16x16x32_bf16 v[52:55], v[128:131], v[76:79], v[52:55]
    ds_read_b128 v[112:115], v32 offset:8192
    ds_read_b128 v[116:119], v32 offset:8448
    ds_read_b128 v[120:123], v32 offset:10240
    ds_read_b128 v[124:127], v32 offset:10496
    s_waitcnt lgkmcnt(8)
    v_mfma_f32_16x16x32_bf16 v[40:43], v[132:135], v[80:83], v[40:43]
    v_mfma_f32_16x16x32_bf16 v[44:47], v[132:135], v[84:87], v[44:47]
    v_mfma_f32_16x16x32_bf16 v[48:51], v[132:135], v[88:91], v[48:51]
    v_mfma_f32_16x16x32_bf16 v[52:55], v[132:135], v[92:95], v[52:55]
    ds_read_b128 v[64:67], v32 offset:16384
    ds_read_b128 v[68:71], v32 offset:16640
    ds_read_b128 v[72:75], v32 offset:18432
    ds_read_b128 v[76:79], v32 offset:18688
    s_waitcnt lgkmcnt(8)
    v_mfma_f32_16x16x32_bf16 v[40:43], v[136:139], v[96:99], v[40:43]
    v_mfma_f32_16x16x32_bf16 v[44:47], v[136:139], v[100:103], v[44:47]
    v_mfma_f32_16x16x32_bf16 v[48:51], v[136:139], v[104:107], v[48:51]
    v_mfma_f32_16x16x32_bf16 v[52:55], v[136:139], v[108:111], v[52:55]
    ds_read_b128 v[80:83], v32 offset:24576
    ds_read_b128 v[84:87], v32 offset:24832
    ds_read_b128 v[88:91], v32 offset:26624
    ds_read_b128 v[92:95], v32 offset:26880
    s_waitcnt lgkmcnt(8)
    v_mfma_f32_16x16x32_bf16 v[40:43], v[140:143], v[112:115], v[40:43]
    v_mfma_f32_16x16x32_bf16 v[44:47], v[140:143], v[116:119], v[44:47]
    v_mfma_f32_16x16x32_bf16 v[48:51], v[140:143], v[120:123], v[48:51]
    v_mfma_f32_16x16x32_bf16 v[52:55], v[140:143], v[124:127], v[52:55]
    s_waitcnt lgkmcnt(4)
    v_mfma_f32_16x16x32_bf16 v[40:43], v[144:147], v[64:67], v[40:43]
    v_mfma_f32_16x16x32_bf16 v[44:47], v[144:147], v[68:71], v[44:47]
    v_mfma_f32_16x16x32_bf16 v[48:51], v[144:147], v[72:75], v[48:51]
    v_mfma_f32_16x16x32_bf16 v[52:55], v[144:147], v[76:79], v[52:55]
    s_waitcnt lgkmcnt(0)
    v_mfma_f32_16x16x32_bf16 v[40:43], v[148:151], v[80:83], v[40:43]
    v_mfma_f32_16x16x32_bf16 v[44:47], v[148:151], v[84:87], v[44:47]
    v_mfma_f32_16x16x32_bf16 v[48:51], v[148:151], v[88:91], v[48:51]
    v_mfma_f32_16x16x32_bf16 v[52:55], v[148:151], v[92:95], v[52:55]
    s_lshl_b32 s80, s5, 11
    s_add_u32 s80, s80, 147456
    v_add_u32 v35, s80, v4
    s_cmp_eq_u32 s86, 1
    s_cbranch_scc1 L_k1_31
    s_nop 1
    ds_write_b128 v35, v[48:51]
    ds_write_b128 v35, v[52:55] offset:1024
    s_branch L_kd_32
L_k1_31:
    ds_write_b128 v35, v[40:43]
    ds_write_b128 v35, v[44:47] offset:1024
    v_mov_b32 v40, v48
    v_mov_b32 v41, v49
    v_mov_b32 v42, v50
    v_mov_b32 v43, v51
    v_mov_b32 v44, v52
    v_mov_b32 v45, v53
    v_mov_b32 v46, v54
    v_mov_b32 v47, v55
L_kd_32:
    s_waitcnt lgkmcnt(0)
    s_barrier
    s_xor_b32 s80, s5, 4
    s_lshl_b32 s80, s80, 11
    s_add_u32 s80, s80, 147456
    v_add_u32 v35, s80, v4
    ds_read_b128 v[64:67], v35
    ds_read_b128 v[68:71], v35 offset:1024
    s_waitcnt lgkmcnt(0)
    v_add_f32 v40, v40, v64
    v_add_f32 v41, v41, v65
    v_add_f32 v42, v42, v66
    v_add_f32 v43, v43, v67
    v_add_f32 v44, v44, v68
    v_add_f32 v45, v45, v69
    v_add_f32 v46, v46, v70
    v_add_f32 v47, v47, v71
    v_add_f32 v40, v40, v152
    v_add_f32 v41, v41, v153
    v_add_f32 v42, v42, v154
    v_add_f32 v43, v43, v155
    v_add_f32 v44, v44, v156
    v_add_f32 v45, v45, v157
    v_add_f32 v46, v46, v158
    v_add_f32 v47, v47, v159
    v_fma_f32 v40, v16, v40, v160
    v_fma_f32 v41, v17, v41, v161
    v_fma_f32 v42, v18, v42, v162
    v_fma_f32 v43, v19, v43, v163
    v_fma_f32 v44, v16, v44, v164
    v_fma_f32 v45, v17, v45, v165
    v_fma_f32 v46, v18, v46, v166
    v_fma_f32 v47, v19, v47, v167
    v_cvt_pk_bf16_f32 v88, v40, v41
    v_cvt_pk_bf16_f32 v89, v42, v43
    v_cvt_pk_bf16_f32 v90, v44, v45
    v_cvt_pk_bf16_f32 v91, v46, v47
    buffer_store_dwordx2 v[88:89], v36, s[16:19], s79 offen
    s_add_u32 s79, s79, 16384
    buffer_store_dwordx2 v[90:91], v36, s[16:19], s79 offen
    s_cmp_lg_u32 s2, 0
    s_cbranch_scc1 L_fin_33
    s_cmp_lg_u32 s5, 0
    s_cbranch_scc1 L_fin_33
    v_mov_b32 v14, s4
    v_mov_b32 v15, 0
    s_mov_b64 s[98:99], exec
    s_mov_b64 exec, 1
    buffer_store_dword v14, v15, s[12:15], 0 offen sc1
    s_mov_b64 exec, s[98:99]
L_fin_33:
L_END:
    s_endpgm
.section .rodata,"a"
.p2align 6
.amdhsa_kernel adaLN_cond__ssm_conv_s4__mixer_s_mlp__prompt_kernel
  .amdhsa_next_free_vgpr 256
  .amdhsa_next_free_sgpr 102
  .amdhsa_accum_offset 256
  .amdhsa_group_segment_fixed_size 0
  .amdhsa_kernarg_size 152
  .amdhsa_user_sgpr_count 2
  .amdhsa_user_sgpr_kernarg_segment_ptr 1
  .amdhsa_system_sgpr_workgroup_id_x 1
  .amdhsa_float_denorm_mode_32 3
.end_amdhsa_kernel
```
